```python
import torch

def _softmax(x, axis=-1):
    return torch.softmax(x, dim=axis)
def _gelu(x):
    return torch.nn.functional.gelu(x, approximate="tanh")
def _silu(x):
    return torch.nn.functional.silu(x)
def _sigmoid(x):
    return torch.sigmoid(x)
def _layernorm(x, axis=-1, eps=1e-5):
    m = x.mean(dim=axis, keepdim=True)
    v = x.var(dim=axis, keepdim=True, unbiased=False)
    return (x - m) / torch.sqrt(v + eps)
def _scatter_add(tgt, idx, src, axis=0):
    return tgt.clone().index_add_(axis, idx, src)
def _segment_sum(src, seg, n):
    out = torch.zeros((n,) + src.shape[1:], dtype=src.dtype)
    return out.index_add_(0, seg, src)
def _pad(x, pw):
    flat = tuple(v for pair in reversed(pw) for v in pair)
    return torch.nn.functional.pad(x, flat)

kernel_name = 'recurrent_scan__softmax_full_mha__mixer_s_mlp__prompt'

def setup_inputs():

    _w = (lambda a: (lambda t: t.to(torch.bfloat16) if t.is_floating_point() else t)(torch.as_tensor(a)))
    def _A_setup():
        B, S, D = 1, 2048, 576
        return {
            "x": _w((lambda *s: torch.randn(*s, dtype=torch.bfloat16) * 0.05)(B, S, D)),
            "wqkv": _w((lambda *s: torch.randn(*s, dtype=torch.bfloat16) * 0.05)(D, 3 * D)),
            "wo": _w((lambda *s: torch.randn(*s, dtype=torch.bfloat16) * 0.05)(D, D)),
        }
    _A_in = _A_setup()

    def _B_setup():
        B, S, D, F = 1, 2048, 576, 4608
        return {
            "x":  _w((lambda *s: torch.randn(*s, dtype=torch.bfloat16) * 0.05)(B, S, D)),
            "w1": _w((lambda *s: torch.randn(*s, dtype=torch.bfloat16) * 3.2)(D, D) * (D ** -0.5)),
            "w2": _w((lambda *s: torch.randn(*s, dtype=torch.bfloat16) * 3.2)(D, D) * (D ** -0.5)),
            "w3": _w((lambda *s: torch.randn(*s, dtype=torch.bfloat16) * 3.2)(D, F) * (D ** -0.5)),
            "w4": _w((lambda *s: torch.randn(*s, dtype=torch.bfloat16) * 3.2)(F, D) * (F ** -0.5)),
        }
    _B_in = _B_setup()

    return {
        "A_x": _A_in["x"],
        "A_wqkv": _A_in["wqkv"],
        "A_wo": _A_in["wo"],
        "B_x": _B_in["x"],
        "B_w1": _B_in["w1"],
        "B_w2": _B_in["w2"],
        "B_w3": _B_in["w3"],
        "B_w4": _B_in["w4"],
    }

def reference(A_x, A_wqkv, A_wo, B_x, B_w1, B_w2, B_w3, B_w4):
    def _A_ref(x, wqkv, wo):
        B, S, D = x.shape
        H = 32; Dh = D // H
        qkv = (lambda x, *d: x.permute(*d))((x @ wqkv).reshape(B, S, 3, H, Dh), 2, 0, 3, 1, 4)
        q, k, v = qkv[0], qkv[1], qkv[2]
        scale = Dh ** -0.5
        scores = torch.einsum("bhqd,bhkd->bhqk", q, k) * scale
        p = _softmax(scores, axis=-1)
        o = torch.einsum("bhqk,bhkd->bhqd", p, v)
        return (lambda x, *d: x.permute(*d))(o, 0, 2, 1, 3).reshape(B, S, D) @ wo

    def _B_ref(x, w1, w2, w3, w4):
        B, S, D = x.shape
        h = _gelu(_layernorm(x, axis=-1) @ w1)
        c = D // 4
        g0 = _pad(h[:, :, 0*c:1*c], ((0, 0), (1, 0), (0, 0)))[:, :S, :]
        g1 = _pad(h[:, :, 1*c:2*c], ((0, 0), (0, 1), (0, 0)))[:, 1:, :]
        g2 = _pad(h[:, :, 2*c:3*c], ((0, 0), (2, 0), (0, 0)))[:, :S, :]
        g3 = _pad(h[:, :, 3*c:   ], ((0, 0), (0, 2), (0, 0)))[:, 2:, :]
        hs = torch.concatenate([g0, g1, g2, g3], axis=-1) @ w2
        x1 = x + hs
        h2 = _gelu(_layernorm(x1, axis=-1) @ w3) @ w4
        return x1 + h2

    x = A_x
    xn = _layernorm(x, axis=-1)
    s = _A_ref(xn, A_wqkv, A_wo)
    g = _silu(_B_ref(xn, B_w1, B_w2, B_w3, B_w4))
    return x + s * g
```

```asm
; @launch kernel=k1_kernel grid=(256,1,1) block=(512,1,1) lds=153600
; @launch kernel=k234_kernel grid=(256,1,1) block=(512,1,1) lds=163840
.amdgcn_target "amdgcn-amd-amdhsa--gfx950"
.text
.globl k1_kernel
.p2align 8
.type k1_kernel,@function
k1_kernel:
  s_cmp_ge_u32 s2, 256
  s_cbranch_scc1 K1_EXIT
  s_load_dwordx4 s[4:7], s[0:1], 0
  s_load_dwordx4 s[8:11], s[0:1], 32
  s_load_dwordx2 s[12:13], s[0:1], 80
  s_getpc_b64 s[66:67]
PF_k1:
  s_sub_u32 s66, s66, PF_k1-k1_kernel
  s_subb_u32 s67, s67, 0
  v_lshlrev_b32 v220, 7, v0
  v_min_u32 v220, CODE_END-k1_kernel-4, v220
  v_mov_b32 v221, s67
  v_add_co_u32 v220, vcc, s66, v220
  s_nop 1
  v_addc_co_u32 v221, vcc, 0, v221, vcc
  global_load_dword v222, v[220:221], off
  v_and_b32 v1, 63, v0
  v_lshrrev_b32 v2, 6, v0
  s_and_b32 s50, s2, 7
  s_lshr_b32 s51, s2, 3
  v_readfirstlane_b32 s44, v2
  s_and_b32 s52, s50, 1
  s_lshl_b32 s52, s52, 3
  s_and_b32 s53, s51, 7
  s_add_u32 s37, s52, s53
  s_lshr_b32 s39, s50, 1
  s_lshr_b32 s40, s51, 3
  s_lshl_b32 s52, s39, 2
  s_add_u32 s38, s52, s40
  s_movk_i32 s41, 3456
  s_cmp_eq_u32 s39, 3
  s_cselect_b32 s41, 1152, s41
  s_cselect_b32 s52, s40, s38
  s_mul_i32 s52, s52, 288
  s_and_b32 s42, s52, 63
  s_andn2_b32 s52, s52, 63
  v_lshrrev_b32 v2, 4, v1
  v_and_b32 v3, 7, v1
  v_xor_b32 v2, v2, v3
  v_lshrrev_b32 v3, 3, v1
  v_mul_u32_u24 v3, 1152, v3
  v_lshl_add_u32 v4, v2, 4, v3
  v_xor_b32 v5, 64, v4
  v_lshrrev_b32 v2, 2, v1
  v_mul_lo_u32 v2, v2, s41
  v_and_b32 v7, 3, v1
  v_lshl_add_u32 v6, v7, 4, v2
  s_and_b32 s36, s44, 3
  s_lshl_b32 s46, s37, 2
  s_add_u32 s46, s46, s36
  s_mul_i32 s46, s46, 36864
  s_lshl_b32 s54, s36, 4
  s_mul_i32 s47, s54, s41
  s_lshl_b32 s57, s41, 6
  s_lshl_b32 s58, s36, 12
  s_mul_i32 s59, s36, 5120
  s_add_u32 s59, s59, 16384
  s_mov_b32 s45, 0
  s_and_b32 s65, s51, 7
  s_lshl_b32 s64, s40, 1
  s_add_u32 s65, s65, s64
  s_sub_u32 s64, s65, 9
  s_cmp_ge_u32 s65, 9
  s_cselect_b32 s65, s64, s65
  s_mov_b32 s65, 0
  s_lshl_b32 s64, s65, 7
  s_add_u32 s46, s46, s64
  s_mul_i32 s64, s65, s57
  s_add_u32 s47, s47, s64
  s_mul_i32 s64, s57, 9
  s_mov_b32 s18, 2359296
  s_mov_b32 s19, 0x20000
  s_mul_i32 s22, s41, 576
  s_sub_u32 s22, s22, s52
  s_mov_b32 s23, 0x20000
  s_cmp_eq_u32 s42, 0
  s_cselect_b32 s32, -1, 0xcccccccc
  s_cselect_b32 s34, 0x33333333, -1
  s_mov_b32 s33, s32
  s_mov_b32 s35, s34
  s_cmp_eq_u32 s39, 3
  s_waitcnt lgkmcnt(0)
  s_mov_b32 s16, s4
  s_mov_b32 s17, s5
  s_cselect_b32 s20, s8, s6
  s_cselect_b32 s21, s9, s7
  s_add_u32 s20, s20, s52
  s_addc_u32 s21, s21, 0
  s_cmp_lt_u32 s44, 4
  s_cbranch_scc1 K1_NODMA
K1_PRE:
  s_add_u32 s60, s58, s45
  s_add_u32 s61, s59, s45
  s_add_u32 m0, s61, 0
  s_mov_b64 exec, s[32:33]
  buffer_load_dwordx4 v6, s[20:23], s47 offen offset:0 lds
  s_mov_b64 exec, -1
  s_add_u32 m0, s61, 960
  s_nop 0
  buffer_load_dwordx4 v6, s[20:23], s47 offen offset:64 lds
  s_add_u32 m0, s61, 1920
  s_nop 0
  buffer_load_dwordx4 v6, s[20:23], s47 offen offset:128 lds
  s_add_u32 m0, s61, 2880
  s_nop 0
  buffer_load_dwordx4 v6, s[20:23], s47 offen offset:192 lds
  s_add_u32 m0, s61, 3840
  s_mov_b64 exec, s[34:35]
  buffer_load_dwordx4 v6, s[20:23], s47 offen offset:256 lds
  s_mov_b64 exec, -1
  s_add_u32 m0, s60, 0
  s_add_u32 s62, s46, 0
  buffer_load_dwordx4 v4, s[16:19], s62 offen lds
  s_add_u32 m0, s60, 1024
  s_add_u32 s62, s46, 9216
  buffer_load_dwordx4 v5, s[16:19], s62 offen lds
  s_add_u32 m0, s60, 2048
  s_add_u32 s62, s46, 18432
  buffer_load_dwordx4 v4, s[16:19], s62 offen lds
  s_add_u32 m0, s60, 3072
  s_add_u32 s62, s46, 27648
  buffer_load_dwordx4 v5, s[16:19], s62 offen lds
  s_add_u32 s46, s46, 128
  s_add_u32 s47, s47, s57
  s_add_u32 s65, s65, 1
  s_cmp_eq_u32 s65, 9
  s_cselect_b32 s62, 1152, 0
  s_sub_u32 s46, s46, s62
  s_cmp_eq_u32 s65, 9
  s_cselect_b32 s62, s64, 0
  s_sub_u32 s47, s47, s62
  s_add_u32 s45, s45, 36864
  s_cmp_eq_u32 s45, 147456
  s_cselect_b32 s45, 0, s45
  s_cmp_lt_u32 s45, 73728
  s_cbranch_scc1 K1_PRE
  s_mov_b32 s28, s10
  s_mov_b32 s29, s11
  s_mov_b32 s30, 663552
  s_mov_b32 s31, 0x20000
  s_lshl_b32 s48, s38, 4
  s_add_u32 s48, s48, s37
  s_lshl_b32 s48, s48, 2
  s_add_u32 s48, s48, s36
  s_mul_i32 s53, s48, 3641
  s_lshr_b32 s53, s53, 16
  s_mul_i32 s54, s53, 18
  s_sub_u32 s54, s48, s54
  s_mul_i32 s66, s54, 36
  s_add_u32 s66, s66, s53
  s_lshl_b32 s66, s66, 10
  s_lshr_b32 s55, s54, 2
  s_mul_i32 s55, s55, 144
  s_and_b32 s56, s54, 3
  s_lshl_b32 s56, s56, 5
  s_add_u32 s55, s55, s56
  s_sub_u32 s56, s54, 16
  s_mul_i32 s56, s56, 288
  s_add_u32 s56, s56, 128
  s_cmp_lt_u32 s54, 16
  s_cselect_b32 s55, s55, s56
  s_cselect_b32 s56, 0, 128
  s_mul_i32 s55, s55, 1152
  s_lshl_b32 s53, s53, 5
  s_add_u32 s55, s55, s53
  s_cmp_lt_u32 s48, 648
  s_cselect_b32 s55, s55, 1073741824
  v_lshrrev_b32 v2, 1, v1
  v_lshrrev_b32 v3, 5, v1
  v_mul_lo_u32 v17, v3, s56
  v_add_u32 v2, v2, v17
  v_mul_u32_u24 v2, 1152, v2
  v_and_b32 v17, 1, v1
  v_lshl_add_u32 v2, v17, 4, v2
  buffer_load_dwordx4 v[28:31], v2, s[28:31], s55 offen
  v_mov_b32 v26, 0x3f803f80
  v_mov_b32 v27, 0x3f803f80
  s_movk_i32 s53, 4128
  s_cmp_eq_u32 s42, 0
  s_cselect_b32 s53, s53, 0
  s_add_u32 s53, s53, s59
  v_lshrrev_b32 v2, 2, v1
  v_lshlrev_b32 v2, 6, v2
  v_lshl_add_u32 v2, v7, 3, v2
  v_add_u32 v2, s53, v2
  ds_write_b64 v2, v[26:27]
  ds_write_b64 v2, v[26:27] offset:36864
  v_add_u32 v2, 73728, v2
  ds_write_b64 v2, v[26:27]
  ds_write_b64 v2, v[26:27] offset:36864
K1_NODMA:
  v_lshrrev_b32 v3, 5, v1
  s_cmp_eq_u32 s42, 0
  s_cselect_b32 s49, 288, 0
  v_and_b32 v2, 31, v1
  v_bfe_u32 v17, v1, 1, 3
  v_xor_b32 v17, v17, v3
  v_lshlrev_b32 v17, 4, v17
  v_lshl_add_u32 v17, v2, 7, v17
  v_add_u32 v8, s58, v17
  v_xor_b32 v9, 32, v8
  v_xor_b32 v10, 64, v8
  v_xor_b32 v11, 0x60, v8
  v_bfe_u32 v17, v1, 2, 2
  v_lshl_add_u32 v17, v3, 3, v17
  v_lshlrev_b32 v17, 6, v17
  v_add_u32 v17, 16384, v17
  v_lshl_add_u32 v18, v7, 3, s42
  v_bfe_u32 v19, v1, 4, 1
  s_movk_i32 s53, 64
  s_movk_i32 s56, 960
  s_movk_i32 s55, 256
  s_cmp_lt_u32 s39, 2
  s_cselect_b32 s53, 72, s53
  s_cselect_b32 s54, 40, 32
  s_cselect_b32 s55, 32, s55
  s_cselect_b32 s63, 64, 0
  v_mad_u32_u24 v2, v19, s54, v18
  v_lshrrev_b32 v3, 6, v2
  v_mad_u32_u24 v3, v3, s56, v17
  v_add_u32 v12, v3, v2
  v_add_u32 v2, s53, v2
  v_lshrrev_b32 v3, 6, v2
  v_mad_u32_u24 v3, v3, s56, v17
  v_add_u32 v13, v3, v2
  v_add_u32 v2, s53, v2
  v_lshrrev_b32 v3, 6, v2
  v_mad_u32_u24 v3, v3, s56, v17
  v_add_u32 v14, v3, v2
  v_add_u32 v2, s53, v2
  v_lshrrev_b32 v3, 6, v2
  v_mad_u32_u24 v3, v3, s56, v17
  v_add_u32 v15, v3, v2
  v_mad_u32_u24 v2, v7, s63, v18
  v_add_u32 v2, s55, v2
  v_lshl_add_u32 v18, v7, 3, s49
  v_cmp_eq_u32 vcc, 1, v19
  s_nop 1
  v_cndmask_b32 v2, v2, v18, vcc
  v_lshrrev_b32 v3, 6, v2
  v_mad_u32_u24 v3, v3, s56, v17
  v_add_u32 v16, v3, v2
  v_mov_b32 v32, 0
  v_mov_b32 v33, 0
  v_mov_b32 v34, 0
  v_mov_b32 v35, 0
  s_mov_b32 s43, 0
  s_mov_b32 s63, 36864
  s_cmp_lt_u32 s44, 4
  s_cbranch_scc0 K1_HELP
  v_mov_b32 v24, 0
  v_mov_b32 v25, 0
  v_mfma_f32_32x32x16_bf16 v[96:111], v[32:35], v[32:35], 0
  v_mfma_f32_32x32x16_bf16 v[112:127], v[32:35], v[32:35], 0
  v_mfma_f32_32x32x16_bf16 v[128:143], v[32:35], v[32:35], 0
  v_mfma_f32_32x32x16_bf16 v[144:159], v[32:35], v[32:35], 0
  v_mfma_f32_32x32x16_bf16 v[160:175], v[32:35], v[32:35], 0
  s_barrier
  ds_read_b64_tr_b16 v[48:49], v12 offset:0
  ds_read_b64_tr_b16 v[50:51], v12 offset:256
  ds_read_b128 v[32:35], v8
  ds_read_b64_tr_b16 v[52:53], v13 offset:0
  ds_read_b64_tr_b16 v[54:55], v13 offset:256
  ds_read_b64_tr_b16 v[56:57], v14 offset:0
  ds_read_b64_tr_b16 v[58:59], v14 offset:256
  ds_read_b64_tr_b16 v[60:61], v15 offset:0
  ds_read_b64_tr_b16 v[62:63], v15 offset:256
  ds_read_b64_tr_b16 v[64:65], v16 offset:0
  ds_read_b64_tr_b16 v[66:67], v16 offset:256
  s_cmp_eq_u32 s39, 2
  s_cbranch_scc1 K1_V_LOOP
K1_WX_LOOP:
  s_waitcnt lgkmcnt(8)
  v_mfma_f32_32x32x16_bf16 v[96:111], v[48:51], v[32:35], v[96:111]
  ds_read_b64_tr_b16 v[68:69], v12 offset:5120
  ds_read_b64_tr_b16 v[70:71], v12 offset:5376
  ds_read_b128 v[36:39], v9
  s_waitcnt lgkmcnt(9)
  v_mfma_f32_32x32x16_bf16 v[112:127], v[52:55], v[32:35], v[112:127]
  ds_read_b64_tr_b16 v[72:73], v13 offset:5120
  ds_read_b64_tr_b16 v[74:75], v13 offset:5376
  s_waitcnt lgkmcnt(9)
  v_mfma_f32_32x32x16_bf16 v[128:143], v[56:59], v[32:35], v[128:143]
  ds_read_b64_tr_b16 v[76:77], v14 offset:5120
  ds_read_b64_tr_b16 v[78:79], v14 offset:5376
  s_waitcnt lgkmcnt(9)
  v_mfma_f32_32x32x16_bf16 v[144:159], v[60:63], v[32:35], v[144:159]
  ds_read_b64_tr_b16 v[80:81], v15 offset:5120
  ds_read_b64_tr_b16 v[82:83], v15 offset:5376
  s_waitcnt lgkmcnt(9)
  v_mfma_f32_32x32x16_bf16 v[160:175], v[64:67], v[32:35], v[160:175]
  ds_read_b64_tr_b16 v[84:85], v16 offset:5120
  ds_read_b64_tr_b16 v[86:87], v16 offset:5376
  s_waitcnt lgkmcnt(8)
  v_mfma_f32_32x32x16_bf16 v[96:111], v[68:71], v[36:39], v[96:111]
  ds_read_b64_tr_b16 v[48:49], v12 offset:10240
  ds_read_b64_tr_b16 v[50:51], v12 offset:10496
  ds_read_b128 v[40:43], v10
  s_waitcnt lgkmcnt(9)
  v_mfma_f32_32x32x16_bf16 v[112:127], v[72:75], v[36:39], v[112:127]
  ds_read_b64_tr_b16 v[52:53], v13 offset:10240
  ds_read_b64_tr_b16 v[54:55], v13 offset:10496
  s_waitcnt lgkmcnt(9)
  v_mfma_f32_32x32x16_bf16 v[128:143], v[76:79], v[36:39], v[128:143]
  ds_read_b64_tr_b16 v[56:57], v14 offset:10240
  ds_read_b64_tr_b16 v[58:59], v14 offset:10496
  s_waitcnt lgkmcnt(9)
  v_mfma_f32_32x32x16_bf16 v[144:159], v[80:83], v[36:39], v[144:159]
  ds_read_b64_tr_b16 v[60:61], v15 offset:10240
  ds_read_b64_tr_b16 v[62:63], v15 offset:10496
  s_waitcnt lgkmcnt(9)
  v_mfma_f32_32x32x16_bf16 v[160:175], v[84:87], v[36:39], v[160:175]
  ds_read_b64_tr_b16 v[64:65], v16 offset:10240
  ds_read_b64_tr_b16 v[66:67], v16 offset:10496
  s_waitcnt lgkmcnt(8)
  v_mfma_f32_32x32x16_bf16 v[96:111], v[48:51], v[40:43], v[96:111]
  ds_read_b64_tr_b16 v[68:69], v12 offset:15360
  ds_read_b64_tr_b16 v[70:71], v12 offset:15616
  ds_read_b128 v[44:47], v11
  s_add_u32 s43, s43, 1
  s_and_b32 s53, s43, 3
  s_cmp_eq_u32 s53, 0
  s_cselect_b32 s53, 4294856704, s63
  v_add_u32 v12, s53, v12
  s_waitcnt lgkmcnt(9)
  v_mfma_f32_32x32x16_bf16 v[112:127], v[52:55], v[40:43], v[112:127]
  ds_read_b64_tr_b16 v[72:73], v13 offset:15360
  ds_read_b64_tr_b16 v[74:75], v13 offset:15616
  v_add_u32 v13, s53, v13
  v_add_u32 v8, s53, v8
  s_waitcnt lgkmcnt(9)
  v_mfma_f32_32x32x16_bf16 v[128:143], v[56:59], v[40:43], v[128:143]
  ds_read_b64_tr_b16 v[76:77], v14 offset:15360
  ds_read_b64_tr_b16 v[78:79], v14 offset:15616
  v_add_u32 v14, s53, v14
  v_add_u32 v9, s53, v9
  s_waitcnt lgkmcnt(9)
  v_mfma_f32_32x32x16_bf16 v[144:159], v[60:63], v[40:43], v[144:159]
  ds_read_b64_tr_b16 v[80:81], v15 offset:15360
  ds_read_b64_tr_b16 v[82:83], v15 offset:15616
  v_add_u32 v15, s53, v15
  v_add_u32 v10, s53, v10
  s_waitcnt lgkmcnt(9)
  v_mfma_f32_32x32x16_bf16 v[160:175], v[64:67], v[40:43], v[160:175]
  ds_read_b64_tr_b16 v[84:85], v16 offset:15360
  ds_read_b64_tr_b16 v[86:87], v16 offset:15616
  v_add_u32 v16, s53, v16
  v_add_u32 v11, s53, v11
  s_waitcnt lgkmcnt(8)
  v_dot2c_f32_bf16 v24, v32, v32
  v_dot2c_f32_bf16 v25, v33, v33
  v_dot2c_f32_bf16 v24, v34, v34
  v_dot2c_f32_bf16 v25, v35, v35
  v_dot2c_f32_bf16 v24, v36, v36
  v_dot2c_f32_bf16 v25, v37, v37
  v_dot2c_f32_bf16 v24, v38, v38
  v_dot2c_f32_bf16 v25, v39, v39
  v_dot2c_f32_bf16 v24, v40, v40
  v_dot2c_f32_bf16 v25, v41, v41
  v_dot2c_f32_bf16 v24, v42, v42
  v_dot2c_f32_bf16 v25, v43, v43
  v_dot2c_f32_bf16 v24, v44, v44
  v_dot2c_f32_bf16 v25, v45, v45
  v_dot2c_f32_bf16 v24, v46, v46
  v_dot2c_f32_bf16 v25, v47, v47
  s_barrier
  s_waitcnt lgkmcnt(8)
  v_mfma_f32_32x32x16_bf16 v[96:111], v[68:71], v[44:47], v[96:111]
  ds_read_b64_tr_b16 v[48:49], v12 offset:0
  ds_read_b64_tr_b16 v[50:51], v12 offset:256
  ds_read_b128 v[32:35], v8
  s_waitcnt lgkmcnt(9)
  v_mfma_f32_32x32x16_bf16 v[112:127], v[72:75], v[44:47], v[112:127]
  ds_read_b64_tr_b16 v[52:53], v13 offset:0
  ds_read_b64_tr_b16 v[54:55], v13 offset:256
  s_waitcnt lgkmcnt(9)
  v_mfma_f32_32x32x16_bf16 v[128:143], v[76:79], v[44:47], v[128:143]
  ds_read_b64_tr_b16 v[56:57], v14 offset:0
  ds_read_b64_tr_b16 v[58:59], v14 offset:256
  s_waitcnt lgkmcnt(9)
  v_mfma_f32_32x32x16_bf16 v[144:159], v[80:83], v[44:47], v[144:159]
  ds_read_b64_tr_b16 v[60:61], v15 offset:0
  ds_read_b64_tr_b16 v[62:63], v15 offset:256
  s_waitcnt lgkmcnt(9)
  v_mfma_f32_32x32x16_bf16 v[160:175], v[84:87], v[44:47], v[160:175]
  ds_read_b64_tr_b16 v[64:65], v16 offset:0
  ds_read_b64_tr_b16 v[66:67], v16 offset:256
  s_cmp_lt_u32 s43, 9
  s_cbranch_scc1 K1_WX_LOOP
  s_cmp_eq_u32 s39, 0
  s_cselect_b32 s55, 1051597459, 1.0
  v_mov_b32 v3, s55
  s_cmp_eq_u32 s39, 3
  s_cselect_b64 vcc, -1, 0
  v_lshrrev_b32 v19, 5, v1
  v_lshlrev_b32 v17, 4, v19
  v_add_u32 v17, 147456, v17
  s_lshl_b32 s60, s37, 2
  s_add_u32 s60, s60, s36
  s_mov_b32 s64, 0
  v_add_f32 v24, v24, v25
  v_mov_b32 v8, v24
  s_nop 1
  v_permlane32_swap_b32 v24, v8
  v_add_f32 v8, v24, v8
  s_mov_b32 s53, 987991609
  s_mov_b32 s54, 925353388
  v_mul_f32 v24, s53, v168
  v_mul_f32 v8, s53, v8
  v_fma_f32 v8, -v24, v24, v8
  v_max_f32 v8, 0, v8
  v_add_f32 v25, s54, v8
  v_rsq_f32 v25, v25
  s_nop 0
  v_mul_f32 v9, v25, v25
  v_fma_f32 v9, v9, v8, s54
  v_rsq_f32 v9, v9
  s_nop 0
  v_cndmask_b32 v9, v3, v9, vcc
  v_mul_f32 v2, v25, v9
  v_mul_f32 v4, -v24, v2
  s_barrier
  ds_read_b128 v[176:179], v17 offset:512
  ds_read_b128 v[180:183], v17 offset:544
  ds_read_b128 v[184:187], v17 offset:576
  ds_read_b128 v[188:191], v17 offset:608
  ds_read_b128 v[192:195], v17 offset:640
  ds_read_b128 v[196:199], v17 offset:672
  ds_read_b128 v[200:203], v17 offset:704
  ds_read_b128 v[204:207], v17 offset:736
  ds_read_b128 v[32:35], v17 offset:0
  ds_read_b128 v[36:39], v17 offset:32
  ds_read_b128 v[40:43], v17 offset:64
  ds_read_b128 v[44:47], v17 offset:96
  ds_read_b128 v[48:51], v17 offset:128
  ds_read_b128 v[52:55], v17 offset:160
  ds_read_b128 v[56:59], v17 offset:192
  ds_read_b128 v[60:63], v17 offset:224
  ds_read_b128 v[64:67], v17 offset:256
  ds_read_b128 v[68:71], v17 offset:288
  ds_read_b128 v[72:75], v17 offset:320
  ds_read_b128 v[76:79], v17 offset:352
  ds_read_b128 v[80:83], v17 offset:384
  ds_read_b128 v[84:87], v17 offset:416
  ds_read_b128 v[88:91], v17 offset:448
  ds_read_b128 v[92:95], v17 offset:480
  s_waitcnt lgkmcnt(15)
  v_pk_add_f32 v[176:177], v[176:177], v[184:185]
  v_pk_add_f32 v[192:193], v[192:193], v[200:201]
  v_pk_add_f32 v[178:179], v[178:179], v[186:187]
  v_pk_add_f32 v[194:195], v[194:195], v[202:203]
  v_pk_add_f32 v[180:181], v[180:181], v[188:189]
  v_pk_add_f32 v[196:197], v[196:197], v[204:205]
  v_pk_add_f32 v[182:183], v[182:183], v[190:191]
  v_pk_add_f32 v[198:199], v[198:199], v[206:207]
  v_pk_add_f32 v[208:209], v[176:177], v[192:193]
  v_pk_add_f32 v[210:211], v[178:179], v[194:195]
  v_pk_add_f32 v[212:213], v[180:181], v[196:197]
  v_pk_add_f32 v[214:215], v[182:183], v[198:199]
  v_and_b32 v18, 31, v1
  v_lshlrev_b32 v20, 4, v1
  s_cmp_eq_u32 s39, 3
  s_cbranch_scc1 K1_W1
  s_lshl_b32 s61, s40, 3
  s_cmp_eq_u32 s39, 0
  s_cbranch_scc0 K1_KADDR
  s_mov_b32 s24, s12
  s_mov_b32 s25, s13
  s_mov_b32 s26, 2359296
  s_mov_b32 s27, 0x20000
  s_mov_b32 s56, 65536
  s_lshl_b32 s57, s61, 16
  s_lshl_b32 s62, s60, 10
  s_add_u32 s57, s57, s62
  s_movk_i32 s58, 8192
  s_lshl_b32 s59, s61, 13
  s_lshl_b32 s62, s60, 7
  s_add_u32 s59, s59, s62
  s_add_u32 s59, s59, 2097152
  s_branch K1_QKST
K1_KADDR:
  s_add_u32 s24, s12, 3145728
  s_addc_u32 s25, s13, 0
  s_mov_b32 s26, 4849664
  s_mov_b32 s27, 0x20000
  s_mov_b32 s56, 151552
  s_mul_i32 s57, s61, 151552
  s_lshr_b32 s62, s60, 3
  s_mul_i32 s62, s62, 18944
  s_add_u32 s57, s57, s62
  s_and_b32 s62, s60, 7
  s_lshl_b32 s63, s62, 7
  s_add_u32 s59, s57, s63
  s_add_u32 s59, s59, 8192
  s_lshl_b32 s62, s62, 10
  s_add_u32 s57, s57, s62
  s_mov_b32 s58, 151552
K1_QKST:
  s_lshl_b32 s63, s58, 1
  v_mul_lo_u32 v21, v19, s63
  v_lshl_add_u32 v21, v18, 2, v21
  s_mov_b32 s62, 0
  s_waitcnt lgkmcnt(0)
K1_QKL:
  s_set_gpr_idx_on s64, gpr_idx(SRC0)
  v_pk_mul_f32 v[176:177], v[32:33], v[4:5] op_sel_hi:[1,0]
  v_pk_mul_f32 v[178:179], v[34:35], v[4:5] op_sel_hi:[1,0]
  v_pk_mul_f32 v[180:181], v[36:37], v[4:5] op_sel_hi:[1,0]
  v_pk_mul_f32 v[182:183], v[38:39], v[4:5] op_sel_hi:[1,0]
  v_pk_mul_f32 v[184:185], v[40:41], v[4:5] op_sel_hi:[1,0]
  v_pk_mul_f32 v[186:187], v[42:43], v[4:5] op_sel_hi:[1,0]
  v_pk_mul_f32 v[188:189], v[44:45], v[4:5] op_sel_hi:[1,0]
  v_pk_mul_f32 v[190:191], v[46:47], v[4:5] op_sel_hi:[1,0]
  v_pk_fma_f32 v[176:177], v[96:97], v[2:3], v[176:177] op_sel_hi:[1,0,1]
  v_pk_fma_f32 v[178:179], v[98:99], v[2:3], v[178:179] op_sel_hi:[1,0,1]
  v_pk_fma_f32 v[180:181], v[100:101], v[2:3], v[180:181] op_sel_hi:[1,0,1]
  v_pk_fma_f32 v[182:183], v[102:103], v[2:3], v[182:183] op_sel_hi:[1,0,1]
  v_pk_fma_f32 v[184:185], v[104:105], v[2:3], v[184:185] op_sel_hi:[1,0,1]
  v_pk_fma_f32 v[186:187], v[106:107], v[2:3], v[186:187] op_sel_hi:[1,0,1]
  v_pk_fma_f32 v[188:189], v[108:109], v[2:3], v[188:189] op_sel_hi:[1,0,1]
  v_pk_fma_f32 v[190:191], v[110:111], v[2:3], v[190:191] op_sel_hi:[1,0,1]
  s_set_gpr_idx_off
  v_cvt_pk_bf16_f32 v8, v176, v177
  v_cvt_pk_bf16_f32 v9, v178, v179
  v_cvt_pk_bf16_f32 v10, v180, v181
  v_cvt_pk_bf16_f32 v11, v182, v183
  v_cvt_pk_bf16_f32 v12, v184, v185
  v_cvt_pk_bf16_f32 v13, v186, v187
  v_cvt_pk_bf16_f32 v14, v188, v189
  v_cvt_pk_bf16_f32 v15, v190, v191
  buffer_store_dwordx4 v[8:11], v20, s[24:27], s57 offen sc1
  s_add_u32 s57, s57, s56
  buffer_store_dwordx4 v[12:15], v20, s[24:27], s57 offen sc1
  s_add_u32 s57, s57, s56
  v_dot2_f32_bf16 v176, v8, v8, 0
  v_dot2_f32_bf16 v176, v9, v9, v176
  v_dot2_f32_bf16 v176, v10, v10, v176
  v_dot2_f32_bf16 v176, v11, v11, v176
  v_dot2_f32_bf16 v177, v12, v12, 0
  v_dot2_f32_bf16 v177, v13, v13, v177
  v_dot2_f32_bf16 v177, v14, v14, v177
  v_dot2_f32_bf16 v177, v15, v15, v177
  s_add_u32 s64, s64, 16
  s_nop 1
  v_permlane32_swap_b32 v176, v177
  s_set_gpr_idx_on s62, gpr_idx(DST)
  v_add_f32 v192, v176, v177
  s_set_gpr_idx_off
  s_add_u32 s62, s62, 1
  s_cmp_lt_u32 s62, 4
  s_cbranch_scc1 K1_QKL
  v_pk_mul_f32 v[176:177], v[208:209], v[4:5] op_sel_hi:[1,0]
  v_pk_mul_f32 v[178:179], v[210:211], v[4:5] op_sel_hi:[1,0]
  v_pk_mul_f32 v[180:181], v[212:213], v[4:5] op_sel_hi:[1,0]
  v_pk_mul_f32 v[182:183], v[214:215], v[4:5] op_sel_hi:[1,0]
  v_pk_fma_f32 v[176:177], v[160:161], v[2:3], v[176:177] op_sel_hi:[1,0,1]
  v_pk_fma_f32 v[178:179], v[162:163], v[2:3], v[178:179] op_sel_hi:[1,0,1]
  v_pk_fma_f32 v[180:181], v[164:165], v[2:3], v[180:181] op_sel_hi:[1,0,1]
  v_pk_fma_f32 v[182:183], v[166:167], v[2:3], v[182:183] op_sel_hi:[1,0,1]
  v_cvt_pk_bf16_f32 v8, v176, v177
  v_cvt_pk_bf16_f32 v9, v178, v179
  v_cvt_pk_bf16_f32 v10, v180, v181
  v_cvt_pk_bf16_f32 v11, v182, v183
  buffer_store_dword v8, v21, s[24:27], s59 offen
  s_add_u32 s59, s59, s58
  buffer_store_dword v9, v21, s[24:27], s59 offen
  s_add_u32 s59, s59, s58
  s_add_u32 s59, s59, s63
  buffer_store_dword v10, v21, s[24:27], s59 offen
  s_add_u32 s59, s59, s58
  buffer_store_dword v11, v21, s[24:27], s59 offen
  s_cmp_eq_u32 s39, 0
  s_cbranch_scc1 K1_END
  v_dot2_f32_bf16 v196, v8, v8, 0
  v_dot2_f32_bf16 v197, v9, v9, 0
  v_dot2_f32_bf16 v198, v10, v10, 0
  v_dot2_f32_bf16 v199, v11, v11, 0
  v_max_f32_dpp v192, v192, v192 row_ror:8 row_mask:0xf bank_mask:0xf
  v_max_f32_dpp v193, v193, v193 row_ror:8 row_mask:0xf bank_mask:0xf
  v_max_f32_dpp v194, v194, v194 row_ror:8 row_mask:0xf bank_mask:0xf
  v_max_f32_dpp v195, v195, v195 row_ror:8 row_mask:0xf bank_mask:0xf
  v_max_f32_dpp v196, v196, v196 row_ror:8 row_mask:0xf bank_mask:0xf
  v_max_f32_dpp v197, v197, v197 row_ror:8 row_mask:0xf bank_mask:0xf
  v_max_f32_dpp v198, v198, v198 row_ror:8 row_mask:0xf bank_mask:0xf
  v_max_f32_dpp v199, v199, v199 row_ror:8 row_mask:0xf bank_mask:0xf
  v_max_f32_dpp v192, v192, v192 row_ror:4 row_mask:0xf bank_mask:0xf
  v_max_f32_dpp v193, v193, v193 row_ror:4 row_mask:0xf bank_mask:0xf
  v_max_f32_dpp v194, v194, v194 row_ror:4 row_mask:0xf bank_mask:0xf
  v_max_f32_dpp v195, v195, v195 row_ror:4 row_mask:0xf bank_mask:0xf
  v_max_f32_dpp v196, v196, v196 row_ror:4 row_mask:0xf bank_mask:0xf
  v_max_f32_dpp v197, v197, v197 row_ror:4 row_mask:0xf bank_mask:0xf
  v_max_f32_dpp v198, v198, v198 row_ror:4 row_mask:0xf bank_mask:0xf
  v_max_f32_dpp v199, v199, v199 row_ror:4 row_mask:0xf bank_mask:0xf
  v_max_f32_dpp v192, v192, v192 row_ror:2 row_mask:0xf bank_mask:0xf
  v_max_f32_dpp v193, v193, v193 row_ror:2 row_mask:0xf bank_mask:0xf
  v_max_f32_dpp v194, v194, v194 row_ror:2 row_mask:0xf bank_mask:0xf
  v_max_f32_dpp v195, v195, v195 row_ror:2 row_mask:0xf bank_mask:0xf
  v_max_f32_dpp v196, v196, v196 row_ror:2 row_mask:0xf bank_mask:0xf
  v_max_f32_dpp v197, v197, v197 row_ror:2 row_mask:0xf bank_mask:0xf
  v_max_f32_dpp v198, v198, v198 row_ror:2 row_mask:0xf bank_mask:0xf
  v_max_f32_dpp v199, v199, v199 row_ror:2 row_mask:0xf bank_mask:0xf
  v_max_f32_dpp v192, v192, v192 row_ror:1 row_mask:0xf bank_mask:0xf
  v_max_f32_dpp v193, v193, v193 row_ror:1 row_mask:0xf bank_mask:0xf
  v_max_f32_dpp v194, v194, v194 row_ror:1 row_mask:0xf bank_mask:0xf
  v_max_f32_dpp v195, v195, v195 row_ror:1 row_mask:0xf bank_mask:0xf
  v_max_f32_dpp v196, v196, v196 row_ror:1 row_mask:0xf bank_mask:0xf
  v_max_f32_dpp v197, v197, v197 row_ror:1 row_mask:0xf bank_mask:0xf
  v_max_f32_dpp v198, v198, v198 row_ror:1 row_mask:0xf bank_mask:0xf
  v_max_f32_dpp v199, v199, v199 row_ror:1 row_mask:0xf bank_mask:0xf
  v_mov_b32 v176, v192
  v_mov_b32 v177, v193
  v_mov_b32 v178, v194
  v_mov_b32 v179, v195
  v_mov_b32 v180, v196
  v_mov_b32 v181, v197
  v_mov_b32 v182, v198
  v_mov_b32 v183, v199
  v_permlane16_swap_b32 v192, v176
  v_permlane16_swap_b32 v193, v177
  v_permlane16_swap_b32 v194, v178
  v_permlane16_swap_b32 v195, v179
  v_permlane16_swap_b32 v196, v180
  v_permlane16_swap_b32 v197, v181
  v_permlane16_swap_b32 v198, v182
  v_permlane16_swap_b32 v199, v183
  v_max_f32 v192, v192, v176
  v_max_f32 v193, v193, v177
  v_max_f32 v194, v194, v178
  v_max_f32 v195, v195, v179
  v_max_f32 v196, v196, v180
  v_max_f32 v197, v197, v181
  v_max_f32 v198, v198, v182
  v_max_f32 v199, v199, v183
  s_add_u32 s24, s12, 2359296
  s_addc_u32 s25, s13, 0
  s_mov_b32 s26, 16384
  s_mov_b32 s27, 0x20000
  s_lshl_b32 s53, s61, 8
  s_lshl_b32 s54, s60, 2
  s_add_u32 s53, s53, s54
  s_add_u32 s54, s53, 8192
  v_lshlrev_b32 v20, 8, v19
  v_lshlrev_b32 v21, 9, v19
  s_mov_b32 exec_lo, 1
  s_mov_b32 exec_hi, 1
  buffer_store_dword v192, v20, s[24:27], s53 offen offset:0
  buffer_store_dword v196, v21, s[24:27], s54 offen offset:0
  buffer_store_dword v193, v20, s[24:27], s53 offen offset:512
  buffer_store_dword v197, v21, s[24:27], s54 offen offset:256
  buffer_store_dword v194, v20, s[24:27], s53 offen offset:1024
  buffer_store_dword v198, v21, s[24:27], s54 offen offset:1024
  buffer_store_dword v195, v20, s[24:27], s53 offen offset:1536
  buffer_store_dword v199, v21, s[24:27], s54 offen offset:1280
  s_branch K1_END
K1_HELP:
  v_and_b32 v2, 15, v1
  v_cmp_eq_u32 vcc, v2, v19
  s_nop 1
  v_cndmask_b32 v20, 0, v26, vcc
  v_mov_b32 v24, 0
  v_mov_b32 v25, 0
  s_mul_i32 s53, s36, 5120
  v_add_u32 v16, s53, v16
  s_set_gpr_idx_on s36, gpr_idx(SRC0)
  v_mov_b32 v17, v12
  s_set_gpr_idx_off
  v_mov_b32 v21, v20
  v_mov_b32 v22, v20
  v_mov_b32 v23, v20
  v_add_u32 v12, 0, v17
  v_mov_b32 v176, 0
  v_mov_b32 v177, 0
  v_mov_b32 v178, 0
  v_mov_b32 v179, 0
  v_mov_b32 v180, 0
  v_mov_b32 v181, 0
  v_mov_b32 v182, 0
  v_mov_b32 v183, 0
  v_mov_b32 v184, 0
  v_mov_b32 v185, 0
  v_mov_b32 v186, 0
  v_mov_b32 v187, 0
  v_mov_b32 v188, 0
  v_mov_b32 v189, 0
  v_mov_b32 v190, 0
  v_mov_b32 v191, 0
  s_waitcnt vmcnt(10) lgkmcnt(0)
  s_barrier
  s_setprio 2
K1_HL:
  ds_read_b64_tr_b16 v[48:49], v12 offset:0
  ds_read_b64_tr_b16 v[50:51], v12 offset:256
  ds_read_b64_tr_b16 v[52:53], v12 offset:5120
  ds_read_b64_tr_b16 v[54:55], v12 offset:5376
  ds_read_b64_tr_b16 v[56:57], v12 offset:10240
  ds_read_b64_tr_b16 v[58:59], v12 offset:10496
  ds_read_b64_tr_b16 v[60:61], v12 offset:15360
  ds_read_b64_tr_b16 v[62:63], v12 offset:15616
  ds_read_b64_tr_b16 v[64:65], v16 offset:0
  ds_read_b64_tr_b16 v[66:67], v16 offset:256
  s_add_u32 s43, s43, 1
  s_and_b32 s53, s43, 3
  s_cmp_eq_u32 s53, 0
  s_cselect_b32 s53, 4294856704, s63
  v_add_u32 v12, s53, v12
  v_add_u32 v16, s53, v16
  s_cmp_lt_u32 s43, 8
  s_cbranch_scc0 K1_HND0
  s_add_u32 s60, s58, s45
  s_add_u32 s61, s59, s45
  s_add_u32 m0, s61, 0
  s_mov_b64 exec, s[32:33]
  buffer_load_dwordx4 v6, s[20:23], s47 offen offset:0 lds
  s_mov_b64 exec, -1
  s_add_u32 m0, s61, 960
  s_nop 0
  buffer_load_dwordx4 v6, s[20:23], s47 offen offset:64 lds
  s_add_u32 m0, s61, 1920
  s_nop 0
  buffer_load_dwordx4 v6, s[20:23], s47 offen offset:128 lds
K1_HND0:
  s_cmp_lt_u32 s43, 8
  s_cbranch_scc0 K1_HND1
  s_add_u32 m0, s61, 2880
  s_nop 0
  buffer_load_dwordx4 v6, s[20:23], s47 offen offset:192 lds
  s_add_u32 m0, s61, 3840
  s_mov_b64 exec, s[34:35]
  buffer_load_dwordx4 v6, s[20:23], s47 offen offset:256 lds
  s_mov_b64 exec, -1
  s_add_u32 m0, s60, 0
  s_add_u32 s62, s46, 0
  buffer_load_dwordx4 v4, s[16:19], s62 offen lds
K1_HND1:
  s_cmp_eq_u32 s39, 2
  s_cbranch_scc1 K1_HV
  s_waitcnt lgkmcnt(0)
  v_mfma_f32_16x16x32_bf16 v[176:179], v[48:51], v[20:23], v[176:179]
  v_mfma_f32_16x16x32_bf16 v[176:179], v[52:55], v[20:23], v[176:179]
  v_mfma_f32_16x16x32_bf16 v[176:179], v[56:59], v[20:23], v[176:179]
  v_mfma_f32_16x16x32_bf16 v[176:179], v[60:63], v[20:23], v[176:179]
  v_mfma_f32_16x16x32_bf16 v[180:183], v[64:67], v[20:23], v[180:183]
  s_branch K1_HW0
K1_HV:
  s_waitcnt lgkmcnt(0)
  v_mfma_f32_16x16x32_bf16 v[176:179], v[20:23], v[48:51], v[176:179]
  v_mfma_f32_16x16x32_bf16 v[176:179], v[20:23], v[52:55], v[176:179]
  v_mfma_f32_16x16x32_bf16 v[176:179], v[20:23], v[56:59], v[176:179]
  v_mfma_f32_16x16x32_bf16 v[176:179], v[20:23], v[60:63], v[176:179]
  v_mfma_f32_16x16x32_bf16 v[180:183], v[20:23], v[64:67], v[180:183]
K1_HW0:
  s_cmp_lt_u32 s43, 8
  s_cbranch_scc0 K1_HND2
  s_add_u32 m0, s60, 1024
  s_add_u32 s62, s46, 9216
  buffer_load_dwordx4 v5, s[16:19], s62 offen lds
  s_add_u32 m0, s60, 2048
  s_add_u32 s62, s46, 18432
  buffer_load_dwordx4 v4, s[16:19], s62 offen lds
  s_add_u32 m0, s60, 3072
  s_add_u32 s62, s46, 27648
  buffer_load_dwordx4 v5, s[16:19], s62 offen lds
  s_add_u32 s46, s46, 128
  s_add_u32 s47, s47, s57
  s_add_u32 s65, s65, 1
  s_cmp_eq_u32 s65, 9
  s_cselect_b32 s62, 1152, 0
  s_sub_u32 s46, s46, s62
  s_cmp_eq_u32 s65, 9
  s_cselect_b32 s62, s64, 0
  s_sub_u32 s47, s47, s62
  s_add_u32 s45, s45, 36864
  s_cmp_eq_u32 s45, 147456
  s_cselect_b32 s45, 0, s45
K1_HND2:
K1_HW:
  s_cmp_lt_u32 s43, 8
  s_cbranch_scc1 K1_HW9
  s_waitcnt vmcnt(0)
  s_cmp_lt_u32 s43, 8
  s_cbranch_scc1 K1_HW9
  s_waitcnt vmcnt(0)
K1_HW9:
  s_waitcnt vmcnt(9)
  s_barrier
  s_cmp_lt_u32 s43, 9
  s_cbranch_scc1 K1_HL
  s_lshl_b32 s53, s36, 7
  s_add_u32 s53, s53, 147456
  s_lshl_b32 s54, s36, 6
  s_add_u32 s54, s54, 147968
  s_cmp_eq_u32 s39, 2
  s_cbranch_scc1 K1_HVE
  v_and_b32 v17, 15, v1
  v_lshrrev_b32 v19, 4, v1
  v_lshlrev_b32 v19, 4, v19
  v_lshl_add_u32 v17, v17, 6, v19
  v_add_u32 v17, s53, v17
  v_add_u32 v19, s54, v19
  s_mov_b32 exec_lo, 0x00030003
  s_mov_b32 exec_hi, 0x00030003
  ds_write_b128 v17, v[176:179]
  s_mov_b32 exec_lo, 0x00010001
  s_mov_b32 exec_hi, 0x00010001
  ds_write_b128 v19, v[180:183]
  s_branch K1_HE
K1_HVE:
  v_lshl_add_u32 v17, v1, 2, s53
  v_lshl_add_u32 v19, v1, 2, s54
  s_mov_b64 exec, 0xffff
  ds_write_b32 v17, v176
  ds_write_b32 v17, v177 offset:64
  ds_write_b32 v19, v180
K1_HE:
  s_mov_b64 exec, -1
  s_waitcnt lgkmcnt(0)
  s_barrier
  s_cmp_eq_u32 s39, 3
  s_cbranch_scc0 K1_W2JOB
  s_add_u32 s28, s12, 2490368
  s_addc_u32 s29, s13, 0
  s_mov_b32 s30, 147456
  s_mov_b32 s31, 0x20000
  s_sub_u32 s53, s48, 768
  s_lshl_b32 s53, s53, 10
  v_lshlrev_b32 v2, 4, v1
  v_mov_b32 v4, 0
  v_mov_b32 v5, 0
  v_mov_b32 v6, 0
  v_mov_b32 v7, 0
  buffer_store_dwordx4 v[4:7], v2, s[28:31], s53 offen sc1
  s_branch K1_END
K1_W2JOB:
  s_cmp_lt_u32 s48, 648
  s_cbranch_scc0 K1_END
  s_lshl_b32 s53, s36, 10
  s_add_u32 s53, s53, 149504
  v_lshlrev_b32 v18, 4, v1
  v_add_u32 v19, s53, v18
  ds_write_b128 v19, v[28:31]
  v_lshrrev_b32 v19, 5, v1
  v_lshlrev_b32 v19, 9, v19
  v_bfe_u32 v20, v1, 2, 3
  v_lshl_add_u32 v19, v20, 5, v19
  v_and_b32 v20, 3, v1
  v_lshl_add_u32 v19, v20, 3, v19
  v_add_u32 v19, s53, v19
  ds_read_b64_tr_b16 v[20:21], v19
  ds_read_b64_tr_b16 v[22:23], v19 offset:256
  s_add_u32 s28, s12, 11534336
  s_addc_u32 s29, s13, 0
  s_mov_b32 s30, 663552
  s_mov_b32 s31, 0x20000
  s_waitcnt lgkmcnt(0)
  buffer_store_dwordx4 v[20:23], v18, s[28:31], s66 offen sc1
  s_branch K1_END
K1_W1:
  s_add_u32 s24, s12, 8388608
  s_addc_u32 s25, s13, 0
  s_mov_b32 s26, 2359296
  s_mov_b32 s27, 0x20000
  s_add_u32 s28, s12, 2424832
  s_addc_u32 s29, s13, 0
  s_mov_b32 s30, 16384
  s_mov_b32 s31, 0x20000
  s_lshl_b32 s61, s60, 8
  v_lshlrev_b32 v21, 3, v18
  s_mov_b32 exec_hi, 0
  buffer_store_dwordx2 v[24:25], v21, s[28:31], s61 offen
  s_mov_b64 exec, -1
  v_bfe_u32 v20, v1, 4, 1
  v_mul_u32_u24 v20, 18432, v20
  v_and_b32 v21, 15, v1
  v_lshl_add_u32 v20, v21, 4, v20
  v_lshl_add_u32 v20, v19, 8, v20
  s_mul_i32 s57, s60, 36864
  s_lshl_b32 s58, s40, 12
  s_add_u32 s58, s58, s57
  s_lshr_b32 s62, s40, 1
  s_lshl_b32 s62, s62, 10
  s_add_u32 s57, s57, s62
  s_and_b32 s62, s40, 1
  s_lshl_b32 s62, s62, 9
  s_add_u32 s57, s57, s62
  s_add_u32 s57, s57, 16384
  v_mov_b32 v22, 3184710632
  v_mov_b32 v23, 3222493025
  s_waitcnt lgkmcnt(0)
K1_W1L:
  s_set_gpr_idx_on s64, gpr_idx(SRC0)
  v_pk_mul_f32 v[176:177], v[32:33], v[4:5] op_sel_hi:[1,0]
  v_pk_mul_f32 v[178:179], v[34:35], v[4:5] op_sel_hi:[1,0]
  v_pk_mul_f32 v[180:181], v[36:37], v[4:5] op_sel_hi:[1,0]
  v_pk_mul_f32 v[182:183], v[38:39], v[4:5] op_sel_hi:[1,0]
  v_pk_mul_f32 v[184:185], v[40:41], v[4:5] op_sel_hi:[1,0]
  v_pk_mul_f32 v[186:187], v[42:43], v[4:5] op_sel_hi:[1,0]
  v_pk_mul_f32 v[188:189], v[44:45], v[4:5] op_sel_hi:[1,0]
  v_pk_mul_f32 v[190:191], v[46:47], v[4:5] op_sel_hi:[1,0]
  v_pk_fma_f32 v[176:177], v[96:97], v[2:3], v[176:177] op_sel_hi:[1,0,1]
  v_pk_fma_f32 v[178:179], v[98:99], v[2:3], v[178:179] op_sel_hi:[1,0,1]
  v_pk_fma_f32 v[180:181], v[100:101], v[2:3], v[180:181] op_sel_hi:[1,0,1]
  v_pk_fma_f32 v[182:183], v[102:103], v[2:3], v[182:183] op_sel_hi:[1,0,1]
  v_pk_fma_f32 v[184:185], v[104:105], v[2:3], v[184:185] op_sel_hi:[1,0,1]
  v_pk_fma_f32 v[186:187], v[106:107], v[2:3], v[186:187] op_sel_hi:[1,0,1]
  v_pk_fma_f32 v[188:189], v[108:109], v[2:3], v[188:189] op_sel_hi:[1,0,1]
  v_pk_fma_f32 v[190:191], v[110:111], v[2:3], v[190:191] op_sel_hi:[1,0,1]
  s_set_gpr_idx_off
K1_W1G:
  v_pk_mul_f32 v[192:193], v[176:177], v[176:177]
  v_pk_mul_f32 v[194:195], v[178:179], v[178:179]
  v_pk_mul_f32 v[196:197], v[180:181], v[180:181]
  v_pk_mul_f32 v[198:199], v[182:183], v[182:183]
  v_pk_mul_f32 v[200:201], v[184:185], v[184:185]
  v_pk_mul_f32 v[202:203], v[186:187], v[186:187]
  v_pk_mul_f32 v[204:205], v[188:189], v[188:189]
  v_pk_mul_f32 v[206:207], v[190:191], v[190:191]
  v_pk_fma_f32 v[192:193], v[192:193], v[22:23], v[22:23] op_sel:[0,0,1] op_sel_hi:[1,0,1]
  v_pk_fma_f32 v[194:195], v[194:195], v[22:23], v[22:23] op_sel:[0,0,1] op_sel_hi:[1,0,1]
  v_pk_fma_f32 v[196:197], v[196:197], v[22:23], v[22:23] op_sel:[0,0,1] op_sel_hi:[1,0,1]
  v_pk_fma_f32 v[198:199], v[198:199], v[22:23], v[22:23] op_sel:[0,0,1] op_sel_hi:[1,0,1]
  v_pk_fma_f32 v[200:201], v[200:201], v[22:23], v[22:23] op_sel:[0,0,1] op_sel_hi:[1,0,1]
  v_pk_fma_f32 v[202:203], v[202:203], v[22:23], v[22:23] op_sel:[0,0,1] op_sel_hi:[1,0,1]
  v_pk_fma_f32 v[204:205], v[204:205], v[22:23], v[22:23] op_sel:[0,0,1] op_sel_hi:[1,0,1]
  v_pk_fma_f32 v[206:207], v[206:207], v[22:23], v[22:23] op_sel:[0,0,1] op_sel_hi:[1,0,1]
  v_pk_mul_f32 v[192:193], v[192:193], v[176:177]
  v_pk_mul_f32 v[194:195], v[194:195], v[178:179]
  v_pk_mul_f32 v[196:197], v[196:197], v[180:181]
  v_pk_mul_f32 v[198:199], v[198:199], v[182:183]
  v_pk_mul_f32 v[200:201], v[200:201], v[184:185]
  v_pk_mul_f32 v[202:203], v[202:203], v[186:187]
  v_pk_mul_f32 v[204:205], v[204:205], v[188:189]
  v_pk_mul_f32 v[206:207], v[206:207], v[190:191]
  v_exp_f32 v192, v192
  v_exp_f32 v193, v193
  v_exp_f32 v194, v194
  v_exp_f32 v195, v195
  v_exp_f32 v196, v196
  v_exp_f32 v197, v197
  v_exp_f32 v198, v198
  v_exp_f32 v199, v199
  v_exp_f32 v200, v200
  v_exp_f32 v201, v201
  v_exp_f32 v202, v202
  v_exp_f32 v203, v203
  v_exp_f32 v204, v204
  v_exp_f32 v205, v205
  v_exp_f32 v206, v206
  v_exp_f32 v207, v207
  v_pk_add_f32 v[192:193], v[192:193], 1.0 op_sel_hi:[1,0]
  v_pk_add_f32 v[194:195], v[194:195], 1.0 op_sel_hi:[1,0]
  v_pk_add_f32 v[196:197], v[196:197], 1.0 op_sel_hi:[1,0]
  v_pk_add_f32 v[198:199], v[198:199], 1.0 op_sel_hi:[1,0]
  v_pk_add_f32 v[200:201], v[200:201], 1.0 op_sel_hi:[1,0]
  v_pk_add_f32 v[202:203], v[202:203], 1.0 op_sel_hi:[1,0]
  v_pk_add_f32 v[204:205], v[204:205], 1.0 op_sel_hi:[1,0]
  v_pk_add_f32 v[206:207], v[206:207], 1.0 op_sel_hi:[1,0]
  v_rcp_f32 v192, v192
  v_rcp_f32 v193, v193
  v_rcp_f32 v194, v194
  v_rcp_f32 v195, v195
  v_rcp_f32 v196, v196
  v_rcp_f32 v197, v197
  v_rcp_f32 v198, v198
  v_rcp_f32 v199, v199
  v_rcp_f32 v200, v200
  v_rcp_f32 v201, v201
  v_rcp_f32 v202, v202
  v_rcp_f32 v203, v203
  v_rcp_f32 v204, v204
  v_rcp_f32 v205, v205
  v_rcp_f32 v206, v206
  v_rcp_f32 v207, v207
  v_pk_mul_f32 v[176:177], v[176:177], v[192:193]
  v_pk_mul_f32 v[178:179], v[178:179], v[194:195]
  v_pk_mul_f32 v[180:181], v[180:181], v[196:197]
  v_pk_mul_f32 v[182:183], v[182:183], v[198:199]
  v_pk_mul_f32 v[184:185], v[184:185], v[200:201]
  v_pk_mul_f32 v[186:187], v[186:187], v[202:203]
  v_pk_mul_f32 v[188:189], v[188:189], v[204:205]
  v_pk_mul_f32 v[190:191], v[190:191], v[206:207]
  v_cvt_pk_bf16_f32 v8, v176, v177
  v_cvt_pk_bf16_f32 v9, v178, v179
  v_cvt_pk_bf16_f32 v10, v180, v181
  v_cvt_pk_bf16_f32 v11, v182, v183
  v_cvt_pk_bf16_f32 v12, v184, v185
  v_cvt_pk_bf16_f32 v13, v186, v187
  v_cvt_pk_bf16_f32 v14, v188, v189
  v_cvt_pk_bf16_f32 v15, v190, v191
  s_cmp_eq_u32 s64, 64
  s_cbranch_scc1 K1_W1T
  s_add_u32 s64, s64, 16
  buffer_store_dwordx4 v[8:11], v20, s[24:27], s58 offen sc1
  buffer_store_dwordx4 v[12:15], v20, s[24:27], s58 offen offset:512 sc1
  s_add_u32 s58, s58, 1024
  s_cmp_lt_u32 s64, 64
  s_cbranch_scc1 K1_W1L
  v_pk_mul_f32 v[176:177], v[208:209], v[4:5] op_sel_hi:[1,0]
  v_pk_mul_f32 v[178:179], v[210:211], v[4:5] op_sel_hi:[1,0]
  v_pk_mul_f32 v[180:181], v[212:213], v[4:5] op_sel_hi:[1,0]
  v_pk_mul_f32 v[182:183], v[214:215], v[4:5] op_sel_hi:[1,0]
  v_pk_fma_f32 v[176:177], v[160:161], v[2:3], v[176:177] op_sel_hi:[1,0,1]
  v_pk_fma_f32 v[178:179], v[162:163], v[2:3], v[178:179] op_sel_hi:[1,0,1]
  v_pk_fma_f32 v[180:181], v[164:165], v[2:3], v[180:181] op_sel_hi:[1,0,1]
  v_pk_fma_f32 v[182:183], v[166:167], v[2:3], v[182:183] op_sel_hi:[1,0,1]
  s_branch K1_W1G
K1_W1T:
  buffer_store_dwordx4 v[8:11], v20, s[24:27], s57 offen sc1
  s_branch K1_END
K1_V_LOOP:
  s_waitcnt lgkmcnt(8)
  v_mfma_f32_32x32x16_bf16 v[96:111], v[32:35], v[48:51], v[96:111]
  ds_read_b64_tr_b16 v[68:69], v12 offset:5120
  ds_read_b64_tr_b16 v[70:71], v12 offset:5376
  ds_read_b128 v[36:39], v9
  s_waitcnt lgkmcnt(9)
  v_mfma_f32_32x32x16_bf16 v[112:127], v[32:35], v[52:55], v[112:127]
  ds_read_b64_tr_b16 v[72:73], v13 offset:5120
  ds_read_b64_tr_b16 v[74:75], v13 offset:5376
  s_waitcnt lgkmcnt(9)
  v_mfma_f32_32x32x16_bf16 v[128:143], v[32:35], v[56:59], v[128:143]
  ds_read_b64_tr_b16 v[76:77], v14 offset:5120
  ds_read_b64_tr_b16 v[78:79], v14 offset:5376
  s_waitcnt lgkmcnt(9)
  v_mfma_f32_32x32x16_bf16 v[144:159], v[32:35], v[60:63], v[144:159]
  ds_read_b64_tr_b16 v[80:81], v15 offset:5120
  ds_read_b64_tr_b16 v[82:83], v15 offset:5376
  s_waitcnt lgkmcnt(9)
  v_mfma_f32_32x32x16_bf16 v[160:175], v[32:35], v[64:67], v[160:175]
  ds_read_b64_tr_b16 v[84:85], v16 offset:5120
  ds_read_b64_tr_b16 v[86:87], v16 offset:5376
  s_waitcnt lgkmcnt(8)
  v_mfma_f32_32x32x16_bf16 v[96:111], v[36:39], v[68:71], v[96:111]
  ds_read_b64_tr_b16 v[48:49], v12 offset:10240
  ds_read_b64_tr_b16 v[50:51], v12 offset:10496
  ds_read_b128 v[40:43], v10
  s_waitcnt lgkmcnt(9)
  v_mfma_f32_32x32x16_bf16 v[112:127], v[36:39], v[72:75], v[112:127]
  ds_read_b64_tr_b16 v[52:53], v13 offset:10240
  ds_read_b64_tr_b16 v[54:55], v13 offset:10496
  s_waitcnt lgkmcnt(9)
  v_mfma_f32_32x32x16_bf16 v[128:143], v[36:39], v[76:79], v[128:143]
  ds_read_b64_tr_b16 v[56:57], v14 offset:10240
  ds_read_b64_tr_b16 v[58:59], v14 offset:10496
  s_waitcnt lgkmcnt(9)
  v_mfma_f32_32x32x16_bf16 v[144:159], v[36:39], v[80:83], v[144:159]
  ds_read_b64_tr_b16 v[60:61], v15 offset:10240
  ds_read_b64_tr_b16 v[62:63], v15 offset:10496
  s_waitcnt lgkmcnt(9)
  v_mfma_f32_32x32x16_bf16 v[160:175], v[36:39], v[84:87], v[160:175]
  ds_read_b64_tr_b16 v[64:65], v16 offset:10240
  ds_read_b64_tr_b16 v[66:67], v16 offset:10496
  s_waitcnt lgkmcnt(8)
  v_mfma_f32_32x32x16_bf16 v[96:111], v[40:43], v[48:51], v[96:111]
  ds_read_b64_tr_b16 v[68:69], v12 offset:15360
  ds_read_b64_tr_b16 v[70:71], v12 offset:15616
  ds_read_b128 v[44:47], v11
  s_add_u32 s43, s43, 1
  s_and_b32 s53, s43, 3
  s_cmp_eq_u32 s53, 0
  s_cselect_b32 s53, 4294856704, s63
  v_add_u32 v12, s53, v12
  s_waitcnt lgkmcnt(9)
  v_mfma_f32_32x32x16_bf16 v[112:127], v[40:43], v[52:55], v[112:127]
  ds_read_b64_tr_b16 v[72:73], v13 offset:15360
  ds_read_b64_tr_b16 v[74:75], v13 offset:15616
  v_add_u32 v13, s53, v13
  v_add_u32 v8, s53, v8
  s_waitcnt lgkmcnt(9)
  v_mfma_f32_32x32x16_bf16 v[128:143], v[40:43], v[56:59], v[128:143]
  ds_read_b64_tr_b16 v[76:77], v14 offset:15360
  ds_read_b64_tr_b16 v[78:79], v14 offset:15616
  v_add_u32 v14, s53, v14
  v_add_u32 v9, s53, v9
  s_waitcnt lgkmcnt(9)
  v_mfma_f32_32x32x16_bf16 v[144:159], v[40:43], v[60:63], v[144:159]
  ds_read_b64_tr_b16 v[80:81], v15 offset:15360
  ds_read_b64_tr_b16 v[82:83], v15 offset:15616
  v_add_u32 v15, s53, v15
  v_add_u32 v10, s53, v10
  s_waitcnt lgkmcnt(9)
  v_mfma_f32_32x32x16_bf16 v[160:175], v[40:43], v[64:67], v[160:175]
  ds_read_b64_tr_b16 v[84:85], v16 offset:15360
  ds_read_b64_tr_b16 v[86:87], v16 offset:15616
  v_add_u32 v16, s53, v16
  v_add_u32 v11, s53, v11
  s_waitcnt lgkmcnt(8)
  v_dot2c_f32_bf16 v24, v32, v32
  v_dot2c_f32_bf16 v25, v33, v33
  v_dot2c_f32_bf16 v24, v34, v34
  v_dot2c_f32_bf16 v25, v35, v35
  v_dot2c_f32_bf16 v24, v36, v36
  v_dot2c_f32_bf16 v25, v37, v37
  v_dot2c_f32_bf16 v24, v38, v38
  v_dot2c_f32_bf16 v25, v39, v39
  v_dot2c_f32_bf16 v24, v40, v40
  v_dot2c_f32_bf16 v25, v41, v41
  v_dot2c_f32_bf16 v24, v42, v42
  v_dot2c_f32_bf16 v25, v43, v43
  v_dot2c_f32_bf16 v24, v44, v44
  v_dot2c_f32_bf16 v25, v45, v45
  v_dot2c_f32_bf16 v24, v46, v46
  v_dot2c_f32_bf16 v25, v47, v47
  s_barrier
  s_waitcnt lgkmcnt(8)
  v_mfma_f32_32x32x16_bf16 v[96:111], v[44:47], v[68:71], v[96:111]
  ds_read_b64_tr_b16 v[48:49], v12 offset:0
  ds_read_b64_tr_b16 v[50:51], v12 offset:256
  ds_read_b128 v[32:35], v8
  s_waitcnt lgkmcnt(9)
  v_mfma_f32_32x32x16_bf16 v[112:127], v[44:47], v[72:75], v[112:127]
  ds_read_b64_tr_b16 v[52:53], v13 offset:0
  ds_read_b64_tr_b16 v[54:55], v13 offset:256
  s_waitcnt lgkmcnt(9)
  v_mfma_f32_32x32x16_bf16 v[128:143], v[44:47], v[76:79], v[128:143]
  ds_read_b64_tr_b16 v[56:57], v14 offset:0
  ds_read_b64_tr_b16 v[58:59], v14 offset:256
  s_waitcnt lgkmcnt(9)
  v_mfma_f32_32x32x16_bf16 v[144:159], v[44:47], v[80:83], v[144:159]
  ds_read_b64_tr_b16 v[60:61], v15 offset:0
  ds_read_b64_tr_b16 v[62:63], v15 offset:256
  s_waitcnt lgkmcnt(9)
  v_mfma_f32_32x32x16_bf16 v[160:175], v[44:47], v[84:87], v[160:175]
  ds_read_b64_tr_b16 v[64:65], v16 offset:0
  ds_read_b64_tr_b16 v[66:67], v16 offset:256
  s_cmp_lt_u32 s43, 9
  s_cbranch_scc1 K1_V_LOOP
  s_lshl_b32 s53, s36, 8
  s_add_u32 s53, s53, 148480
  v_and_b32 v18, 31, v1
  v_lshrrev_b32 v19, 5, v1
  v_lshl_add_u32 v17, v19, 4, s53
  v_lshlrev_b32 v16, 2, v18
  v_add_u32 v16, 147456, v16
  v_mov_b32 v26, 0x3f803f80
  v_lshl_add_u32 v15, v18, 2, s53
  s_mov_b32 exec_lo, 0x00010000
  s_mov_b32 exec_hi, 0x00010000
  ds_write_b128 v17, v[160:163] offset:0
  ds_write_b128 v17, v[164:167] offset:32
  ds_write_b128 v17, v[168:171] offset:64
  ds_write_b128 v17, v[172:175] offset:96
  s_mov_b64 exec, -1
  ds_read_b32 v9, v15
  v_add_f32 v24, v24, v25
  v_mov_b32 v8, v24
  s_nop 1
  v_permlane32_swap_b32 v24, v8
  v_add_f32 v8, v24, v8
  s_waitcnt lgkmcnt(0)
  s_mov_b32 s53, 987991609
  s_mov_b32 s54, 925353388
  v_mul_f32 v24, s53, v9
  v_mul_f32 v8, s53, v8
  v_fma_f32 v8, -v24, v24, v8
  v_max_f32 v8, 0, v8
  v_add_f32 v25, s54, v8
  v_rsq_f32 v25, v25
  s_nop 0
  v_mov_b32 v2, v25
  v_mul_f32 v4, -v24, v2
  ds_write_b32 v15, v2
  ds_write_b32 v15, v4 offset:128
  s_add_u32 s24, s12, 3145728
  s_addc_u32 s25, s13, 0
  s_mov_b32 s26, 4849664
  s_mov_b32 s27, 0x20000
  s_lshl_b32 s60, s37, 2
  s_add_u32 s60, s60, s36
  s_mul_i32 s57, s40, 1212416
  s_lshr_b32 s62, s60, 3
  s_mul_i32 s62, s62, 18944
  s_add_u32 s57, s57, s62
  s_and_b32 s62, s60, 7
  s_mul_i32 s62, s62, 1216
  s_add_u32 s57, s57, s62
  s_add_u32 s57, s57, 9216
  s_mov_b32 s58, s57
  s_mov_b32 s56, 151264
  v_mul_u32_u24 v21, 304, v19
  v_lshl_add_u32 v21, v18, 4, v21
  v_mul_u32_u24 v20, 3641, v18
  s_mov_b32 s64, 0
  s_mov_b32 s65, 0
  s_barrier
  ds_read_b32 v72, v16 offset:512
  ds_read_b32 v73, v16 offset:576
  ds_read_b32 v74, v16 offset:640
  ds_read_b32 v75, v16 offset:704
  ds_read_b32 v64, v16 offset:0
  ds_read_b32 v66, v16 offset:128
  ds_read_b32 v68, v16 offset:256
  ds_read_b32 v70, v16 offset:384
  ds_read_b128 v[32:35], v17 offset:0
  ds_read_b128 v[36:39], v17 offset:32
  ds_read_b128 v[40:43], v17 offset:64
  ds_read_b128 v[44:47], v17 offset:96
  ds_read_b128 v[48:51], v17 offset:128
  ds_read_b128 v[52:55], v17 offset:160
  ds_read_b128 v[56:59], v17 offset:192
  ds_read_b128 v[60:63], v17 offset:224
  s_waitcnt lgkmcnt(12)
  v_add_f32 v72, v72, v73
  v_add_f32 v74, v74, v75
  v_add_f32 v72, v72, v74
  s_waitcnt lgkmcnt(0)
K1_VL:
  s_set_gpr_idx_on s64, gpr_idx(SRC0)
  v_pk_mul_f32 v[176:177], v[64:65], v[48:49] op_sel_hi:[0,1]
  v_pk_mul_f32 v[178:179], v[64:65], v[50:51] op_sel_hi:[0,1]
  v_pk_mul_f32 v[180:181], v[64:65], v[52:53] op_sel_hi:[0,1]
  v_pk_mul_f32 v[182:183], v[64:65], v[54:55] op_sel_hi:[0,1]
  v_pk_mul_f32 v[184:185], v[64:65], v[56:57] op_sel_hi:[0,1]
  v_pk_mul_f32 v[186:187], v[64:65], v[58:59] op_sel_hi:[0,1]
  v_pk_mul_f32 v[188:189], v[64:65], v[60:61] op_sel_hi:[0,1]
  v_pk_mul_f32 v[190:191], v[64:65], v[62:63] op_sel_hi:[0,1]
  s_set_gpr_idx_idx s65
  v_pk_fma_f32 v[176:177], v[96:97], v[32:33], v[176:177]
  v_pk_fma_f32 v[178:179], v[98:99], v[34:35], v[178:179]
  v_pk_fma_f32 v[180:181], v[100:101], v[36:37], v[180:181]
  v_pk_fma_f32 v[182:183], v[102:103], v[38:39], v[182:183]
  v_pk_fma_f32 v[184:185], v[104:105], v[40:41], v[184:185]
  v_pk_fma_f32 v[186:187], v[106:107], v[42:43], v[186:187]
  v_pk_fma_f32 v[188:189], v[108:109], v[44:45], v[188:189]
  v_pk_fma_f32 v[190:191], v[110:111], v[46:47], v[190:191]
  s_set_gpr_idx_off
  v_lshrrev_b32 v22, 16, v20
  v_mad_u32_u24 v22, v22, s56, v21
  v_add_u32 v20, 116512, v20
  s_cmp_lt_u32 s64, 8
  s_cselect_b32 exec_lo, -1, 0xffff
  s_cselect_b32 exec_hi, -1, 0xffff
  v_cvt_pk_bf16_f32 v8, v176, v177
  v_cvt_pk_bf16_f32 v9, v178, v179
  v_cvt_pk_bf16_f32 v10, v180, v181
  v_cvt_pk_bf16_f32 v11, v182, v183
  v_cvt_pk_bf16_f32 v12, v184, v185
  v_cvt_pk_bf16_f32 v13, v186, v187
  v_cvt_pk_bf16_f32 v14, v188, v189
  v_cvt_pk_bf16_f32 v15, v190, v191
  s_add_u32 s64, s64, 2
  s_add_u32 s65, s65, 16
  buffer_store_dwordx4 v[8:11], v22, s[24:27], s58 offen
  buffer_store_dwordx4 v[12:15], v22, s[24:27], s58 offen offset:608
  s_add_u32 s58, s58, 512
  s_cmp_lt_u32 s64, 10
  s_cbranch_scc1 K1_VL
  s_mov_b64 exec, -1
  v_lshrrev_b32 v20, 2, v1
  v_mul_u32_u24 v20, 151552, v20
  v_and_b32 v21, 3, v1
  v_mul_u32_u24 v21, 304, v21
  v_add_u32 v20, v20, v21
  v_mov_b32 v176, v26
  v_mov_b32 v177, v26
  v_mov_b32 v178, v26
  v_mov_b32 v179, v26
  s_mov_b32 exec_hi, 0
  buffer_store_dwordx4 v[176:179], v20, s[24:27], s57 offen offset:288
K1_END:
K1_EXIT:
  s_endpgm

.globl k234_kernel
.p2align 8
.type k234_kernel,@function
k234_kernel:
  s_cmp_ge_u32 s2, 256
  s_cbranch_scc1 K2_EXIT
  s_load_dwordx2 s[4:5], s[0:1], 80
  v_and_b32 v1, 63, v0
  v_lshrrev_b32 v2, 6, v0
  s_and_b32 s50, s2, 7
  s_lshr_b32 s51, s2, 3
  v_readfirstlane_b32 s36, v2
  s_lshl_b32 s37, s50, 2
  s_lshr_b32 s52, s51, 3
  s_add_u32 s37, s37, s52
  s_mul_i32 s52, s37, 151552
  v_lshlrev_b32 v2, 4, v1
  s_waitcnt lgkmcnt(0)
  s_add_u32 s8, s4, s52
  s_addc_u32 s9, s5, 0
  s_add_u32 s8, s8, 3145728
  s_addc_u32 s9, s9, 0
  s_mov_b32 s10, 151552
  s_mov_b32 s11, 0x20000
  s_cmp_ge_u32 s36, 4
  s_cbranch_scc1 K2_EXTRA
  s_and_b32 s52, s51, 7
  s_lshl_b32 s52, s52, 3
  s_and_b32 s53, s36, 3
  s_lshl_b32 s54, s53, 1
  s_add_u32 s38, s52, s54
  s_lshr_b32 s39, s36, 2
  v_lshlrev_b32 v3, 2, v1
  v_cmp_gt_u32 vcc, 32, v1
  v_mov_b32 v128, 1073741824
  s_nop 0
  v_cndmask_b32 v128, v128, v3, vcc
  s_mov_b32 s12, s4
  s_mov_b32 s13, s5
  s_mov_b32 s14, 2424832
  s_mov_b32 s15, 0x20000
  s_lshl_b32 s52, s37, 16
  s_lshl_b32 s54, s38, 10
  s_add_u32 s52, s52, s54
  buffer_load_dwordx4 v[4:7], v2, s[12:15], s52 offen
  buffer_load_dwordx4 v[12:15], v2, s[12:15], s52 offen offset:1024
  s_lshl_b32 s52, s37, 13
  s_lshl_b32 s54, s38, 7
  s_add_u32 s52, s52, s54
  s_add_u32 s52, s52, 2097152
  buffer_load_dword v8, v128, s[12:15], s52 offen
  buffer_load_dword v16, v128, s[12:15], s52 offen offset:128
  s_lshl_b32 s52, s37, 8
  s_add_u32 s52, s52, 2359296
  buffer_load_dword v129, v3, s[12:15], s52 offen
  s_add_u32 s52, s52, 8192
  buffer_load_dword v130, v3, s[12:15], s52 offen
  s_mul_i32 s42, s39, 75776
  s_lshl_b32 s53, s53, 10
  s_add_u32 s53, s53, s42
  s_mov_b32 m0, s53
  s_nop 0
  buffer_load_dwordx4 v2, s[8:11], s53 offen lds
  s_add_u32 s53, s53, 4096
  s_mov_b32 m0, s53
  s_nop 0
  buffer_load_dwordx4 v2, s[8:11], s53 offen lds
  s_add_u32 s53, s53, 4096
  s_mov_b32 m0, s53
  s_nop 0
  buffer_load_dwordx4 v2, s[8:11], s53 offen lds
  s_add_u32 s53, s53, 4096
  s_mov_b32 m0, s53
  s_nop 0
  buffer_load_dwordx4 v2, s[8:11], s53 offen lds
  s_add_u32 s53, s53, 4096
  s_mov_b32 m0, s53
  s_nop 0
  buffer_load_dwordx4 v2, s[8:11], s53 offen lds
  s_add_u32 s53, s53, 4096
  s_mov_b32 m0, s53
  s_nop 0
  buffer_load_dwordx4 v2, s[8:11], s53 offen lds
  s_add_u32 s53, s53, 4096
  s_mov_b32 m0, s53
  s_nop 0
  buffer_load_dwordx4 v2, s[8:11], s53 offen lds
  s_add_u32 s53, s53, 4096
  s_mov_b32 m0, s53
  s_nop 0
  buffer_load_dwordx4 v2, s[8:11], s53 offen lds
  s_add_u32 s53, s53, 4096
  s_mov_b32 m0, s53
  s_nop 0
  buffer_load_dwordx4 v2, s[8:11], s53 offen lds
  s_add_u32 s53, s53, 4096
  s_mov_b32 m0, s53
  s_nop 0
  buffer_load_dwordx4 v2, s[8:11], s53 offen lds
  v_add_u32 v124, s42, v2
  v_and_b32 v131, 31, v1
  v_lshl_add_u32 v125, v131, 2, s42
  v_lshrrev_b32 v132, 5, v1
  v_mul_u32_u24 v132, 304, v132
  v_min_u32 v133, 18, v131
  v_add_u32 v134, -20, v131
  v_cmp_gt_u32 vcc, 8, v134
  s_nop 1
  v_cndmask_b32 v133, v133, 0, vcc
  v_lshl_add_u32 v126, v133, 4, v132
  v_add_u32 v126, s42, v126
  s_mov_b32 s44, 0x0007ffff
  s_mov_b32 s45, 0x0007ffff
  v_mov_b32 v29, 0x3f803f80
  v_mov_b32 v30, 0x00003f80
  v_mov_b32 v31, 0
  v_mov_b32 v9, 0
  v_mov_b32 v10, 0
  v_mov_b32 v11, 0
  v_mov_b32 v33, 0x3f803f80
  v_mov_b32 v34, 0x00003f80
  v_mov_b32 v35, 0
  v_mov_b32 v17, 0
  v_mov_b32 v18, 0
  v_mov_b32 v19, 0
  v_mov_b32 v36, 0
  v_mov_b32 v37, 0
  v_mov_b32 v38, 0
  v_mov_b32 v39, 0
  v_mov_b32 v40, 0
  v_mov_b32 v41, 0
  v_mov_b32 v42, 0
  v_mov_b32 v43, 0
  v_mov_b32 v44, 0
  v_mov_b32 v45, 0
  v_mov_b32 v46, 0
  v_mov_b32 v47, 0
  v_mov_b32 v48, 0
  v_mov_b32 v49, 0
  v_mov_b32 v50, 0
  v_mov_b32 v51, 0
  v_mov_b32 v88, 0
  v_mov_b32 v89, 0
  v_mov_b32 v90, 0
  v_mov_b32 v91, 0
  v_mfma_f32_32x32x16_bf16 v[92:107], v[36:39], v[36:39], 0
  v_mfma_f32_32x32x16_bf16 v[108:123], v[36:39], v[36:39], 0
  s_waitcnt vmcnt(10)
  v_dot2_f32_bf16 v133, v8, v8, 0
  v_dot2_f32_bf16 v133, v4, v4, v133
  v_dot2_f32_bf16 v133, v5, v5, v133
  v_dot2_f32_bf16 v133, v6, v6, v133
  v_dot2_f32_bf16 v133, v7, v7, v133
  v_dot2_f32_bf16 v134, v16, v16, 0
  v_dot2_f32_bf16 v134, v12, v12, v134
  v_dot2_f32_bf16 v134, v13, v13, v134
  v_dot2_f32_bf16 v134, v14, v14, v134
  v_dot2_f32_bf16 v134, v15, v15, v134
  v_max_f32_dpp v129, v129, v129 row_ror:8 row_mask:0xf bank_mask:0xf
  v_max_f32_dpp v130, v130, v130 row_ror:8 row_mask:0xf bank_mask:0xf
  s_nop 0
  v_max_f32_dpp v129, v129, v129 row_ror:4 row_mask:0xf bank_mask:0xf
  v_max_f32_dpp v130, v130, v130 row_ror:4 row_mask:0xf bank_mask:0xf
  s_nop 0
  v_max_f32_dpp v129, v129, v129 row_ror:2 row_mask:0xf bank_mask:0xf
  v_max_f32_dpp v130, v130, v130 row_ror:2 row_mask:0xf bank_mask:0xf
  s_nop 0
  v_max_f32_dpp v129, v129, v129 row_ror:1 row_mask:0xf bank_mask:0xf
  v_max_f32_dpp v130, v130, v130 row_ror:1 row_mask:0xf bank_mask:0xf
  v_mov_b32 v135, v133
  v_mov_b32 v136, v134
  s_nop 0
  v_permlane32_swap_b32 v133, v135
  v_permlane32_swap_b32 v134, v136
  v_add_f32 v133, v133, v135
  v_add_f32 v134, v134, v136
  v_mov_b32 v135, v129
  v_mov_b32 v136, v130
  s_nop 0
  v_permlane16_swap_b32 v129, v135
  v_permlane16_swap_b32 v130, v136
  v_max_f32 v129, v129, v135
  v_max_f32 v130, v130, v136
  v_mov_b32 v135, v129
  v_mov_b32 v136, v130
  s_nop 0
  v_permlane32_swap_b32 v129, v135
  v_permlane32_swap_b32 v130, v136
  v_max_f32 v129, v129, v135
  v_max_f32 v130, v130, v136
  v_add_f32 v129, v129, v130
  v_mul_f32 v129, 1065615360, v129
  v_mul_f32 v133, v133, v129
  v_mul_f32 v134, v134, v129
  v_sqrt_f32 v133, v133
  v_sqrt_f32 v134, v134
  v_mov_b32 v135, 1109393408
  v_max_f32 v136, v133, v134
  v_add_f32 v137, v133, v134
  v_cmp_nle_f32 vcc, v136, v135
  v_cmp_u_f32 s[46:47], v137, v137
  s_nop 0
  s_or_b64 vcc, vcc, s[46:47]
  s_mov_b32 s40, 2
  s_waitcnt vmcnt(0)
  s_barrier
  s_cbranch_vccz K2_FAST
  s_barrier
  s_mov_b32 s40, 0
  v_mov_b32 v133, 0xff800000
  v_mov_b32 v134, 0xff800000
  v_mov_b32 v135, v2
  v_lshlrev_b32 v136, 2, v131
  s_mov_b32 s41, 0
K2_MAXLOOP:
  ds_read_b128 v[20:23], v135
  ds_read_b32 v28, v136 offset:8192
  v_add_u32 v135, 1024, v135
  v_add_u32 v136, 128, v136
  s_add_u32 s41, s41, 1
  s_and_b32 s42, s41, 7
  s_cmp_eq_u32 s42, 0
  s_cselect_b32 s42, 10752, 0
  s_cselect_b32 s43, 17920, 0
  v_add_u32 v135, s42, v135
  v_add_u32 v136, s43, v136
  s_waitcnt lgkmcnt(0)
  v_mfma_f32_32x32x16_bf16 v[52:67], v[20:23], v[4:7], 0
  v_mfma_f32_32x32x16_bf16 v[52:67], v[28:31], v[8:11], v[52:67]
  v_mfma_f32_32x32x16_bf16 v[68:83], v[20:23], v[12:15], 0
  v_mfma_f32_32x32x16_bf16 v[68:83], v[28:31], v[16:19], v[68:83]
  s_nop 9
  v_max3_f32 v133, v133, v52, v53
  v_max3_f32 v133, v133, v54, v55
  v_max3_f32 v133, v133, v56, v57
  v_max3_f32 v133, v133, v58, v59
  v_max3_f32 v133, v133, v60, v61
  v_max3_f32 v133, v133, v62, v63
  v_max3_f32 v133, v133, v64, v65
  v_max3_f32 v133, v133, v66, v67
  v_max3_f32 v134, v134, v68, v69
  v_max3_f32 v134, v134, v70, v71
  v_max3_f32 v134, v134, v72, v73
  v_max3_f32 v134, v134, v74, v75
  v_max3_f32 v134, v134, v76, v77
  v_max3_f32 v134, v134, v78, v79
  v_max3_f32 v134, v134, v80, v81
  v_max3_f32 v134, v134, v82, v83
  s_cmp_lt_u32 s41, 64
  s_cbranch_scc1 K2_MAXLOOP
  v_mov_b32 v135, v133
  s_nop 1
  v_permlane32_swap_b32 v133, v135
  v_max_f32 v133, v133, v135
  v_mov_b32 v135, v134
  s_nop 1
  v_permlane32_swap_b32 v134, v135
  v_max_f32 v134, v134, v135
K2_FAST:
  ds_read_b128 v[20:23], v124 offset:0
  ds_read_b32 v28, v125 offset:8192
  s_mov_b64 exec, s[44:45]
  ds_read_b128 v[36:39], v126 offset:9216
  ds_read_b128 v[40:43], v126 offset:9824
  s_mov_b64 exec, -1
  v_cmp_gt_u32 vcc, 32, v1
  v_and_b32 v135, 0xffff0000, v133
  v_sub_f32 v133, v133, v135
  v_and_b32 v136, 0xffff0000, v133
  v_sub_f32 v133, v133, v136
  v_lshrrev_b32 v135, 16, v135
  v_or_b32 v135, v135, v136
  v_xor_b32 v135, 0x80008000, v135
  v_lshrrev_b32 v133, 16, v133
  v_xor_b32 v133, 0x8000, v133
  v_cndmask_b32 v9, 0, v135, vcc
  v_cndmask_b32 v10, 0, v133, vcc
  v_and_b32 v135, 0xffff0000, v134
  v_sub_f32 v134, v134, v135
  v_and_b32 v136, 0xffff0000, v134
  v_sub_f32 v134, v134, v136
  v_lshrrev_b32 v135, 16, v135
  v_or_b32 v135, v135, v136
  v_xor_b32 v135, 0x80008000, v135
  v_lshrrev_b32 v134, 16, v134
  v_xor_b32 v134, 0x8000, v134
  v_cndmask_b32 v17, 0, v135, vcc
  v_cndmask_b32 v18, 0, v134, vcc
  s_waitcnt lgkmcnt(2)
  v_mfma_f32_32x32x16_bf16 v[52:67], v[20:23], v[4:7], 0
  v_mfma_f32_32x32x16_bf16 v[52:67], v[28:31], v[8:11], v[52:67]
  ds_read_b128 v[24:27], v124 offset:1024
  ds_read_b32 v32, v125 offset:8320
  v_mov_b32 v80, 0
  v_mov_b32 v81, 0
  v_mov_b32 v82, 0
  v_mov_b32 v83, 0
  s_mov_b32 s41, 0
  s_setprio 2
  s_nop 7
K2_LOOP:
  s_cmp_eq_u32 s41, 7
  s_cbranch_scc0 K2_NOB3
  v_mov_b32 v128, 153600
  v_mov_b32 v129, 1
  s_mov_b64 exec, 1
  ds_add_u32 v128, v129
  s_mov_b64 exec, -1
K2_NOB3:
  s_sub_u32 s40, s40, 1
  s_cmp_eq_u32 s40, 0
  s_cbranch_scc0 K2_NOBAR
  s_barrier
K2_NOBAR:
  v_exp_f32 v52, v52
  v_exp_f32 v53, v53
  v_cvt_pk_bf16_f32 v90, v80, v81
  v_cvt_pk_bf16_f32 v91, v82, v83
  v_mfma_f32_32x32x16_bf16 v[68:83], v[20:23], v[12:15], 0
  v_exp_f32 v54, v54
  v_exp_f32 v55, v55
  v_exp_f32 v56, v56
  v_exp_f32 v57, v57
  v_cvt_pk_bf16_f32 v84, v52, v53
  v_mfma_f32_32x32x16_bf16 v[68:83], v[28:31], v[16:19], v[68:83]
  v_cvt_pk_bf16_f32 v85, v54, v55
  v_exp_f32 v58, v58
  v_exp_f32 v59, v59
  v_exp_f32 v60, v60
  v_exp_f32 v61, v61
  v_cvt_pk_bf16_f32 v86, v56, v57
  v_mfma_f32_32x32x16_bf16 v[108:123], v[48:51], v[88:91], v[108:123]
  s_mov_b64 exec, s[44:45]
  ds_read_b128 v[44:47], v126 offset:10432
  ds_read_b128 v[48:51], v126 offset:11040
  s_mov_b64 exec, -1
  v_cvt_pk_bf16_f32 v87, v58, v59
  v_exp_f32 v62, v62
  v_exp_f32 v63, v63
  v_exp_f32 v64, v64
  v_exp_f32 v65, v65
  s_waitcnt lgkmcnt(2)
  v_mfma_f32_32x32x16_bf16 v[92:107], v[36:39], v[84:87], v[92:107]
  v_cvt_pk_bf16_f32 v88, v60, v61
  v_cvt_pk_bf16_f32 v89, v62, v63
  v_exp_f32 v66, v66
  v_exp_f32 v67, v67
  v_exp_f32 v68, v68
  v_exp_f32 v69, v69
  v_cvt_pk_bf16_f32 v90, v64, v65
  v_cvt_pk_bf16_f32 v91, v66, v67
  v_mfma_f32_32x32x16_bf16 v[52:67], v[24:27], v[4:7], 0
  ds_read_b128 v[20:23], v124 offset:2048
  ds_read_b32 v28, v125 offset:8448
  v_exp_f32 v70, v70
  v_exp_f32 v71, v71
  v_exp_f32 v72, v72
  v_exp_f32 v73, v73
  v_cvt_pk_bf16_f32 v84, v68, v69
  v_mfma_f32_32x32x16_bf16 v[52:67], v[32:35], v[8:11], v[52:67]
  v_cvt_pk_bf16_f32 v85, v70, v71
  v_exp_f32 v74, v74
  v_exp_f32 v75, v75
  v_exp_f32 v76, v76
  v_exp_f32 v77, v77
  v_cvt_pk_bf16_f32 v86, v72, v73
  v_mfma_f32_32x32x16_bf16 v[92:107], v[40:43], v[88:91], v[92:107]
  v_cvt_pk_bf16_f32 v87, v74, v75
  v_exp_f32 v78, v78
  v_exp_f32 v79, v79
  v_exp_f32 v80, v80
  v_exp_f32 v81, v81
  v_mfma_f32_32x32x16_bf16 v[108:123], v[36:39], v[84:87], v[108:123]
  v_cvt_pk_bf16_f32 v88, v76, v77
  v_cvt_pk_bf16_f32 v89, v78, v79
  v_exp_f32 v82, v82
  v_exp_f32 v83, v83
  v_exp_f32 v52, v52
  v_exp_f32 v53, v53
  v_cvt_pk_bf16_f32 v90, v80, v81
  v_cvt_pk_bf16_f32 v91, v82, v83
  v_mfma_f32_32x32x16_bf16 v[68:83], v[24:27], v[12:15], 0
  v_exp_f32 v54, v54
  v_exp_f32 v55, v55
  v_exp_f32 v56, v56
  v_exp_f32 v57, v57
  v_cvt_pk_bf16_f32 v84, v52, v53
  v_mfma_f32_32x32x16_bf16 v[68:83], v[32:35], v[16:19], v[68:83]
  v_cvt_pk_bf16_f32 v85, v54, v55
  v_exp_f32 v58, v58
  v_exp_f32 v59, v59
  v_exp_f32 v60, v60
  v_exp_f32 v61, v61
  v_cvt_pk_bf16_f32 v86, v56, v57
  v_mfma_f32_32x32x16_bf16 v[108:123], v[40:43], v[88:91], v[108:123]
  s_mov_b64 exec, s[44:45]
  ds_read_b128 v[36:39], v126 offset:11648
  ds_read_b128 v[40:43], v126 offset:12256
  s_mov_b64 exec, -1
  v_cvt_pk_bf16_f32 v87, v58, v59
  v_exp_f32 v62, v62
  v_exp_f32 v63, v63
  v_exp_f32 v64, v64
  v_exp_f32 v65, v65
  s_waitcnt lgkmcnt(2)
  v_mfma_f32_32x32x16_bf16 v[92:107], v[44:47], v[84:87], v[92:107]
  v_cvt_pk_bf16_f32 v88, v60, v61
  v_cvt_pk_bf16_f32 v89, v62, v63
  v_exp_f32 v66, v66
  v_exp_f32 v67, v67
  v_exp_f32 v68, v68
  v_exp_f32 v69, v69
  v_cvt_pk_bf16_f32 v90, v64, v65
  v_cvt_pk_bf16_f32 v91, v66, v67
  v_mfma_f32_32x32x16_bf16 v[52:67], v[20:23], v[4:7], 0
  ds_read_b128 v[24:27], v124 offset:3072
  ds_read_b32 v32, v125 offset:8576
  v_exp_f32 v70, v70
  v_exp_f32 v71, v71
  v_exp_f32 v72, v72
  v_exp_f32 v73, v73
  v_cvt_pk_bf16_f32 v84, v68, v69
  v_mfma_f32_32x32x16_bf16 v[52:67], v[28:31], v[8:11], v[52:67]
  v_cvt_pk_bf16_f32 v85, v70, v71
  v_exp_f32 v74, v74
  v_exp_f32 v75, v75
  v_exp_f32 v76, v76
  v_exp_f32 v77, v77
  v_cvt_pk_bf16_f32 v86, v72, v73
  v_mfma_f32_32x32x16_bf16 v[92:107], v[48:51], v[88:91], v[92:107]
  v_cvt_pk_bf16_f32 v87, v74, v75
  v_exp_f32 v78, v78
  v_exp_f32 v79, v79
  v_exp_f32 v80, v80
  v_exp_f32 v81, v81
  v_mfma_f32_32x32x16_bf16 v[108:123], v[44:47], v[84:87], v[108:123]
  v_cvt_pk_bf16_f32 v88, v76, v77
  v_cvt_pk_bf16_f32 v89, v78, v79
  v_exp_f32 v82, v82
  v_exp_f32 v83, v83
  v_exp_f32 v52, v52
  v_exp_f32 v53, v53
  v_cvt_pk_bf16_f32 v90, v80, v81
  v_cvt_pk_bf16_f32 v91, v82, v83
  v_mfma_f32_32x32x16_bf16 v[68:83], v[20:23], v[12:15], 0
  v_exp_f32 v54, v54
  v_exp_f32 v55, v55
  v_exp_f32 v56, v56
  v_exp_f32 v57, v57
  v_cvt_pk_bf16_f32 v84, v52, v53
  v_mfma_f32_32x32x16_bf16 v[68:83], v[28:31], v[16:19], v[68:83]
  v_cvt_pk_bf16_f32 v85, v54, v55
  v_exp_f32 v58, v58
  v_exp_f32 v59, v59
  v_exp_f32 v60, v60
  v_exp_f32 v61, v61
  v_cvt_pk_bf16_f32 v86, v56, v57
  v_mfma_f32_32x32x16_bf16 v[108:123], v[48:51], v[88:91], v[108:123]
  s_mov_b64 exec, s[44:45]
  ds_read_b128 v[44:47], v126 offset:12864
  ds_read_b128 v[48:51], v126 offset:13472
  s_mov_b64 exec, -1
  v_cvt_pk_bf16_f32 v87, v58, v59
  v_exp_f32 v62, v62
  v_exp_f32 v63, v63
  v_exp_f32 v64, v64
  v_exp_f32 v65, v65
  s_waitcnt lgkmcnt(2)
  v_mfma_f32_32x32x16_bf16 v[92:107], v[36:39], v[84:87], v[92:107]
  v_cvt_pk_bf16_f32 v88, v60, v61
  v_cvt_pk_bf16_f32 v89, v62, v63
  v_exp_f32 v66, v66
  v_exp_f32 v67, v67
  v_exp_f32 v68, v68
  v_exp_f32 v69, v69
  v_cvt_pk_bf16_f32 v90, v64, v65
  v_cvt_pk_bf16_f32 v91, v66, v67
  v_mfma_f32_32x32x16_bf16 v[52:67], v[24:27], v[4:7], 0
  ds_read_b128 v[20:23], v124 offset:4096
  ds_read_b32 v28, v125 offset:8704
  v_exp_f32 v70, v70
  v_exp_f32 v71, v71
  v_exp_f32 v72, v72
  v_exp_f32 v73, v73
  v_cvt_pk_bf16_f32 v84, v68, v69
  v_mfma_f32_32x32x16_bf16 v[52:67], v[32:35], v[8:11], v[52:67]
  v_cvt_pk_bf16_f32 v85, v70, v71
  v_exp_f32 v74, v74
  v_exp_f32 v75, v75
  v_exp_f32 v76, v76
  v_exp_f32 v77, v77
  v_cvt_pk_bf16_f32 v86, v72, v73
  v_mfma_f32_32x32x16_bf16 v[92:107], v[40:43], v[88:91], v[92:107]
  v_cvt_pk_bf16_f32 v87, v74, v75
  v_exp_f32 v78, v78
  v_exp_f32 v79, v79
  v_exp_f32 v80, v80
  v_exp_f32 v81, v81
  v_mfma_f32_32x32x16_bf16 v[108:123], v[36:39], v[84:87], v[108:123]
  v_cvt_pk_bf16_f32 v88, v76, v77
  v_cvt_pk_bf16_f32 v89, v78, v79
  v_exp_f32 v82, v82
  v_exp_f32 v83, v83
  v_exp_f32 v52, v52
  v_exp_f32 v53, v53
  v_cvt_pk_bf16_f32 v90, v80, v81
  v_cvt_pk_bf16_f32 v91, v82, v83
  v_mfma_f32_32x32x16_bf16 v[68:83], v[24:27], v[12:15], 0
  v_exp_f32 v54, v54
  v_exp_f32 v55, v55
  v_exp_f32 v56, v56
  v_exp_f32 v57, v57
  v_cvt_pk_bf16_f32 v84, v52, v53
  v_mfma_f32_32x32x16_bf16 v[68:83], v[32:35], v[16:19], v[68:83]
  v_cvt_pk_bf16_f32 v85, v54, v55
  v_exp_f32 v58, v58
  v_exp_f32 v59, v59
  v_exp_f32 v60, v60
  v_exp_f32 v61, v61
  v_cvt_pk_bf16_f32 v86, v56, v57
  v_mfma_f32_32x32x16_bf16 v[108:123], v[40:43], v[88:91], v[108:123]
  s_mov_b64 exec, s[44:45]
  ds_read_b128 v[36:39], v126 offset:14080
  ds_read_b128 v[40:43], v126 offset:14688
  s_mov_b64 exec, -1
  v_cvt_pk_bf16_f32 v87, v58, v59
  v_exp_f32 v62, v62
  v_exp_f32 v63, v63
  v_exp_f32 v64, v64
  v_exp_f32 v65, v65
  s_waitcnt lgkmcnt(2)
  v_mfma_f32_32x32x16_bf16 v[92:107], v[44:47], v[84:87], v[92:107]
  v_cvt_pk_bf16_f32 v88, v60, v61
  v_cvt_pk_bf16_f32 v89, v62, v63
  v_exp_f32 v66, v66
  v_exp_f32 v67, v67
  v_exp_f32 v68, v68
  v_exp_f32 v69, v69
  v_cvt_pk_bf16_f32 v90, v64, v65
  v_cvt_pk_bf16_f32 v91, v66, v67
  v_mfma_f32_32x32x16_bf16 v[52:67], v[20:23], v[4:7], 0
  ds_read_b128 v[24:27], v124 offset:5120
  ds_read_b32 v32, v125 offset:8832
  v_exp_f32 v70, v70
  v_exp_f32 v71, v71
  v_exp_f32 v72, v72
  v_exp_f32 v73, v73
  v_cvt_pk_bf16_f32 v84, v68, v69
  v_mfma_f32_32x32x16_bf16 v[52:67], v[28:31], v[8:11], v[52:67]
  v_cvt_pk_bf16_f32 v85, v70, v71
  v_exp_f32 v74, v74
  v_exp_f32 v75, v75
  v_exp_f32 v76, v76
  v_exp_f32 v77, v77
  v_cvt_pk_bf16_f32 v86, v72, v73
  v_mfma_f32_32x32x16_bf16 v[92:107], v[48:51], v[88:91], v[92:107]
  v_cvt_pk_bf16_f32 v87, v74, v75
  v_exp_f32 v78, v78
  v_exp_f32 v79, v79
  v_exp_f32 v80, v80
  v_exp_f32 v81, v81
  v_mfma_f32_32x32x16_bf16 v[108:123], v[44:47], v[84:87], v[108:123]
  v_cvt_pk_bf16_f32 v88, v76, v77
  v_cvt_pk_bf16_f32 v89, v78, v79
  v_exp_f32 v82, v82
  v_exp_f32 v83, v83
  v_exp_f32 v52, v52
  v_exp_f32 v53, v53
  v_cvt_pk_bf16_f32 v90, v80, v81
  v_cvt_pk_bf16_f32 v91, v82, v83
  v_mfma_f32_32x32x16_bf16 v[68:83], v[20:23], v[12:15], 0
  v_exp_f32 v54, v54
  v_exp_f32 v55, v55
  v_exp_f32 v56, v56
  v_exp_f32 v57, v57
  v_cvt_pk_bf16_f32 v84, v52, v53
  v_mfma_f32_32x32x16_bf16 v[68:83], v[28:31], v[16:19], v[68:83]
  v_cvt_pk_bf16_f32 v85, v54, v55
  v_exp_f32 v58, v58
  v_exp_f32 v59, v59
  v_exp_f32 v60, v60
  v_exp_f32 v61, v61
  v_cvt_pk_bf16_f32 v86, v56, v57
  v_mfma_f32_32x32x16_bf16 v[108:123], v[48:51], v[88:91], v[108:123]
  s_mov_b64 exec, s[44:45]
  ds_read_b128 v[44:47], v126 offset:15296
  ds_read_b128 v[48:51], v126 offset:15904
  s_mov_b64 exec, -1
  v_cvt_pk_bf16_f32 v87, v58, v59
  v_exp_f32 v62, v62
  v_exp_f32 v63, v63
  v_exp_f32 v64, v64
  v_exp_f32 v65, v65
  s_waitcnt lgkmcnt(2)
  v_mfma_f32_32x32x16_bf16 v[92:107], v[36:39], v[84:87], v[92:107]
  v_cvt_pk_bf16_f32 v88, v60, v61
  v_cvt_pk_bf16_f32 v89, v62, v63
  v_exp_f32 v66, v66
  v_exp_f32 v67, v67
  v_exp_f32 v68, v68
  v_exp_f32 v69, v69
  v_cvt_pk_bf16_f32 v90, v64, v65
  v_cvt_pk_bf16_f32 v91, v66, v67
  v_mfma_f32_32x32x16_bf16 v[52:67], v[24:27], v[4:7], 0
  ds_read_b128 v[20:23], v124 offset:6144
  ds_read_b32 v28, v125 offset:8960
  v_exp_f32 v70, v70
  v_exp_f32 v71, v71
  v_exp_f32 v72, v72
  v_exp_f32 v73, v73
  v_cvt_pk_bf16_f32 v84, v68, v69
  v_mfma_f32_32x32x16_bf16 v[52:67], v[32:35], v[8:11], v[52:67]
  v_cvt_pk_bf16_f32 v85, v70, v71
  v_exp_f32 v74, v74
  v_exp_f32 v75, v75
  v_exp_f32 v76, v76
  v_exp_f32 v77, v77
  v_cvt_pk_bf16_f32 v86, v72, v73
  v_mfma_f32_32x32x16_bf16 v[92:107], v[40:43], v[88:91], v[92:107]
  v_cvt_pk_bf16_f32 v87, v74, v75
  v_exp_f32 v78, v78
  v_exp_f32 v79, v79
  v_exp_f32 v80, v80
  v_exp_f32 v81, v81
  v_mfma_f32_32x32x16_bf16 v[108:123], v[36:39], v[84:87], v[108:123]
  v_cvt_pk_bf16_f32 v88, v76, v77
  v_cvt_pk_bf16_f32 v89, v78, v79
  v_exp_f32 v82, v82
  v_exp_f32 v83, v83
  v_exp_f32 v52, v52
  v_exp_f32 v53, v53
  v_cvt_pk_bf16_f32 v90, v80, v81
  v_cvt_pk_bf16_f32 v91, v82, v83
  v_mfma_f32_32x32x16_bf16 v[68:83], v[24:27], v[12:15], 0
  v_exp_f32 v54, v54
  v_exp_f32 v55, v55
  v_exp_f32 v56, v56
  v_exp_f32 v57, v57
  v_cvt_pk_bf16_f32 v84, v52, v53
  v_mfma_f32_32x32x16_bf16 v[68:83], v[32:35], v[16:19], v[68:83]
  v_cvt_pk_bf16_f32 v85, v54, v55
  v_exp_f32 v58, v58
  v_exp_f32 v59, v59
  v_exp_f32 v60, v60
  v_exp_f32 v61, v61
  v_cvt_pk_bf16_f32 v86, v56, v57
  v_mfma_f32_32x32x16_bf16 v[108:123], v[40:43], v[88:91], v[108:123]
  s_mov_b64 exec, s[44:45]
  ds_read_b128 v[36:39], v126 offset:16512
  ds_read_b128 v[40:43], v126 offset:17120
  s_mov_b64 exec, -1
  v_cvt_pk_bf16_f32 v87, v58, v59
  v_exp_f32 v62, v62
  v_exp_f32 v63, v63
  v_exp_f32 v64, v64
  v_exp_f32 v65, v65
  s_waitcnt lgkmcnt(2)
  v_mfma_f32_32x32x16_bf16 v[92:107], v[44:47], v[84:87], v[92:107]
  v_cvt_pk_bf16_f32 v88, v60, v61
  v_cvt_pk_bf16_f32 v89, v62, v63
  v_exp_f32 v66, v66
  v_exp_f32 v67, v67
  v_exp_f32 v68, v68
  v_exp_f32 v69, v69
  v_cvt_pk_bf16_f32 v90, v64, v65
  v_cvt_pk_bf16_f32 v91, v66, v67
  v_mfma_f32_32x32x16_bf16 v[52:67], v[20:23], v[4:7], 0
  ds_read_b128 v[24:27], v124 offset:7168
  ds_read_b32 v32, v125 offset:9088
  v_exp_f32 v70, v70
  v_exp_f32 v71, v71
  v_exp_f32 v72, v72
  v_exp_f32 v73, v73
  v_cvt_pk_bf16_f32 v84, v68, v69
  v_mfma_f32_32x32x16_bf16 v[52:67], v[28:31], v[8:11], v[52:67]
  v_cvt_pk_bf16_f32 v85, v70, v71
  v_exp_f32 v74, v74
  v_exp_f32 v75, v75
  v_exp_f32 v76, v76
  v_exp_f32 v77, v77
  v_cvt_pk_bf16_f32 v86, v72, v73
  v_mfma_f32_32x32x16_bf16 v[92:107], v[48:51], v[88:91], v[92:107]
  v_cvt_pk_bf16_f32 v87, v74, v75
  v_exp_f32 v78, v78
  v_exp_f32 v79, v79
  v_exp_f32 v80, v80
  v_exp_f32 v81, v81
  v_mfma_f32_32x32x16_bf16 v[108:123], v[44:47], v[84:87], v[108:123]
  v_cvt_pk_bf16_f32 v88, v76, v77
  v_cvt_pk_bf16_f32 v89, v78, v79
  v_exp_f32 v82, v82
  v_exp_f32 v83, v83
  v_exp_f32 v52, v52
  v_exp_f32 v53, v53
  v_cvt_pk_bf16_f32 v90, v80, v81
  v_cvt_pk_bf16_f32 v91, v82, v83
  v_mfma_f32_32x32x16_bf16 v[68:83], v[20:23], v[12:15], 0
  v_exp_f32 v54, v54
  v_exp_f32 v55, v55
  v_exp_f32 v56, v56
  v_exp_f32 v57, v57
  v_cvt_pk_bf16_f32 v84, v52, v53
  v_mfma_f32_32x32x16_bf16 v[68:83], v[28:31], v[16:19], v[68:83]
  v_cvt_pk_bf16_f32 v85, v54, v55
  v_exp_f32 v58, v58
  v_exp_f32 v59, v59
  v_exp_f32 v60, v60
  v_exp_f32 v61, v61
  v_cvt_pk_bf16_f32 v86, v56, v57
  v_mfma_f32_32x32x16_bf16 v[108:123], v[48:51], v[88:91], v[108:123]
  s_mov_b64 exec, s[44:45]
  ds_read_b128 v[44:47], v126 offset:17728
  ds_read_b128 v[48:51], v126 offset:18336
  s_mov_b64 exec, -1
  v_cvt_pk_bf16_f32 v87, v58, v59
  v_exp_f32 v62, v62
  v_exp_f32 v63, v63
  v_exp_f32 v64, v64
  v_exp_f32 v65, v65
  s_waitcnt lgkmcnt(2)
  v_mfma_f32_32x32x16_bf16 v[92:107], v[36:39], v[84:87], v[92:107]
  v_cvt_pk_bf16_f32 v88, v60, v61
  v_cvt_pk_bf16_f32 v89, v62, v63
  v_exp_f32 v66, v66
  v_exp_f32 v67, v67
  v_exp_f32 v68, v68
  v_exp_f32 v69, v69
  v_cvt_pk_bf16_f32 v90, v64, v65
  v_cvt_pk_bf16_f32 v91, v66, v67
  v_mfma_f32_32x32x16_bf16 v[52:67], v[24:27], v[4:7], 0
  ds_read_b128 v[20:23], v124 offset:18944
  ds_read_b32 v28, v125 offset:27136
  v_exp_f32 v70, v70
  v_exp_f32 v71, v71
  v_exp_f32 v72, v72
  v_exp_f32 v73, v73
  v_cvt_pk_bf16_f32 v84, v68, v69
  v_mfma_f32_32x32x16_bf16 v[52:67], v[32:35], v[8:11], v[52:67]
  v_cvt_pk_bf16_f32 v85, v70, v71
  v_exp_f32 v74, v74
  v_exp_f32 v75, v75
  v_exp_f32 v76, v76
  v_exp_f32 v77, v77
  v_cvt_pk_bf16_f32 v86, v72, v73
  v_mfma_f32_32x32x16_bf16 v[92:107], v[40:43], v[88:91], v[92:107]
  v_cvt_pk_bf16_f32 v87, v74, v75
  v_exp_f32 v78, v78
  v_exp_f32 v79, v79
  v_exp_f32 v80, v80
  v_exp_f32 v81, v81
  v_mfma_f32_32x32x16_bf16 v[108:123], v[36:39], v[84:87], v[108:123]
  v_cvt_pk_bf16_f32 v88, v76, v77
  v_cvt_pk_bf16_f32 v89, v78, v79
  v_exp_f32 v82, v82
  v_exp_f32 v83, v83
  v_exp_f32 v52, v52
  v_exp_f32 v53, v53
  v_cvt_pk_bf16_f32 v90, v80, v81
  v_cvt_pk_bf16_f32 v91, v82, v83
  v_mfma_f32_32x32x16_bf16 v[68:83], v[24:27], v[12:15], 0
  v_exp_f32 v54, v54
  v_exp_f32 v55, v55
  v_exp_f32 v56, v56
  v_exp_f32 v57, v57
  v_cvt_pk_bf16_f32 v84, v52, v53
  v_mfma_f32_32x32x16_bf16 v[68:83], v[32:35], v[16:19], v[68:83]
  v_cvt_pk_bf16_f32 v85, v54, v55
  v_exp_f32 v58, v58
  v_exp_f32 v59, v59
  v_exp_f32 v60, v60
  v_exp_f32 v61, v61
  v_cvt_pk_bf16_f32 v86, v56, v57
  v_mfma_f32_32x32x16_bf16 v[108:123], v[40:43], v[88:91], v[108:123]
  s_mov_b64 exec, s[44:45]
  ds_read_b128 v[36:39], v126 offset:28160
  ds_read_b128 v[40:43], v126 offset:28768
  s_mov_b64 exec, -1
  v_cvt_pk_bf16_f32 v87, v58, v59
  v_exp_f32 v62, v62
  v_exp_f32 v63, v63
  v_exp_f32 v64, v64
  v_exp_f32 v65, v65
  s_waitcnt lgkmcnt(2)
  v_mfma_f32_32x32x16_bf16 v[92:107], v[44:47], v[84:87], v[92:107]
  v_cvt_pk_bf16_f32 v88, v60, v61
  v_cvt_pk_bf16_f32 v89, v62, v63
  v_exp_f32 v66, v66
  v_exp_f32 v67, v67
  v_exp_f32 v68, v68
  v_exp_f32 v69, v69
  v_cvt_pk_bf16_f32 v90, v64, v65
  v_cvt_pk_bf16_f32 v91, v66, v67
  v_mfma_f32_32x32x16_bf16 v[52:67], v[20:23], v[4:7], 0
  ds_read_b128 v[24:27], v124 offset:19968
  ds_read_b32 v32, v125 offset:27264
  v_exp_f32 v70, v70
  v_exp_f32 v71, v71
  v_exp_f32 v72, v72
  v_exp_f32 v73, v73
  v_cvt_pk_bf16_f32 v84, v68, v69
  v_mfma_f32_32x32x16_bf16 v[52:67], v[28:31], v[8:11], v[52:67]
  v_cvt_pk_bf16_f32 v85, v70, v71
  v_exp_f32 v74, v74
  v_exp_f32 v75, v75
  v_exp_f32 v76, v76
  v_exp_f32 v77, v77
  v_cvt_pk_bf16_f32 v86, v72, v73
  v_mfma_f32_32x32x16_bf16 v[92:107], v[48:51], v[88:91], v[92:107]
  v_add_u32 v124, 18944, v124
  v_add_u32 v125, 18944, v125
  v_add_u32 v126, 18944, v126
  v_cvt_pk_bf16_f32 v87, v74, v75
  v_exp_f32 v78, v78
  v_exp_f32 v79, v79
  v_exp_f32 v80, v80
  v_exp_f32 v81, v81
  v_mfma_f32_32x32x16_bf16 v[108:123], v[44:47], v[84:87], v[108:123]
  v_cvt_pk_bf16_f32 v88, v76, v77
  v_cvt_pk_bf16_f32 v89, v78, v79
  v_exp_f32 v82, v82
  v_exp_f32 v83, v83
  s_add_u32 s41, s41, 1
  s_cmp_lt_u32 s41, 8
  s_cbranch_scc1 K2_LOOP
  v_cvt_pk_bf16_f32 v90, v80, v81
  v_cvt_pk_bf16_f32 v91, v82, v83
  s_nop 1
  v_mfma_f32_32x32x16_bf16 v[108:123], v[48:51], v[88:91], v[108:123]
  s_add_u32 s24, s4, 33554432
  s_addc_u32 s25, s5, 0
  s_mov_b32 s26, 21233664
  s_mov_b32 s27, 0x20000
  s_mul_i32 s52, s38, 331776
  s_lshr_b32 s53, s37, 1
  s_lshl_b32 s53, s53, 10
  s_add_u32 s53, s53, s52
  s_and_b32 s54, s37, 1
  s_lshl_b32 s54, s54, 9
  s_add_u32 s53, s53, s54
  s_lshr_b32 s54, s37, 4
  s_lshl_b32 s54, s54, 10
  s_add_u32 s52, s52, s54
  s_bfe_u32 s54, s37, 0x20002
  s_lshl_b32 s54, s54, 8
  s_add_u32 s52, s52, s54
  s_and_b32 s54, s37, 3
  s_lshl_b32 s54, s54, 2
  s_add_u32 s52, s52, s54
  s_add_u32 s52, s52, 16384
  v_bfe_u32 v2, v1, 4, 1
  v_mul_u32_u24 v2, 165888, v2
  v_and_b32 v3, 15, v1
  v_lshl_add_u32 v2, v3, 4, v2
  v_lshrrev_b32 v3, 5, v1
  v_lshl_add_u32 v3, v3, 8, v2
  v_mov_b32 v132, v102
  s_nop 1
  v_permlane32_swap_b32 v102, v132
  v_rcp_f32 v132, v102
  s_nop 0
  v_pk_mul_f32 v[92:93], v[92:93], v[132:133] op_sel_hi:[1,0]
  v_pk_mul_f32 v[94:95], v[94:95], v[132:133] op_sel_hi:[1,0]
  v_pk_mul_f32 v[96:97], v[96:97], v[132:133] op_sel_hi:[1,0]
  v_pk_mul_f32 v[98:99], v[98:99], v[132:133] op_sel_hi:[1,0]
  v_pk_mul_f32 v[100:101], v[100:101], v[132:133] op_sel_hi:[1,0]
  v_cvt_pk_bf16_f32 v52, v92, v93
  v_cvt_pk_bf16_f32 v53, v94, v95
  v_cvt_pk_bf16_f32 v54, v96, v97
  v_cvt_pk_bf16_f32 v55, v98, v99
  v_cvt_pk_bf16_f32 v56, v100, v101
  buffer_store_dwordx4 v[52:55], v3, s[24:27], s53 offen sc1
  s_mov_b32 exec_hi, 0
  buffer_store_dword v56, v2, s[24:27], s52 offen sc1
  s_mov_b32 exec_hi, -1
  s_add_u32 s52, s52, 331776
  s_add_u32 s53, s53, 331776
  v_mov_b32 v132, v118
  s_nop 1
  v_permlane32_swap_b32 v118, v132
  v_rcp_f32 v132, v118
  s_nop 0
  v_pk_mul_f32 v[108:109], v[108:109], v[132:133] op_sel_hi:[1,0]
  v_pk_mul_f32 v[110:111], v[110:111], v[132:133] op_sel_hi:[1,0]
  v_pk_mul_f32 v[112:113], v[112:113], v[132:133] op_sel_hi:[1,0]
  v_pk_mul_f32 v[114:115], v[114:115], v[132:133] op_sel_hi:[1,0]
  v_pk_mul_f32 v[116:117], v[116:117], v[132:133] op_sel_hi:[1,0]
  v_cvt_pk_bf16_f32 v68, v108, v109
  v_cvt_pk_bf16_f32 v69, v110, v111
  v_cvt_pk_bf16_f32 v70, v112, v113
  v_cvt_pk_bf16_f32 v71, v114, v115
  v_cvt_pk_bf16_f32 v72, v116, v117
  buffer_store_dwordx4 v[68:71], v3, s[24:27], s53 offen sc1
  s_mov_b32 exec_hi, 0
  buffer_store_dword v72, v2, s[24:27], s52 offen sc1
  s_mov_b32 exec_hi, -1
  s_add_u32 s52, s52, 331776
  s_add_u32 s53, s53, 331776
  s_lshl_b32 s52, s38, 6
  s_add_u32 s52, s52, 4096
  s_barrier
  s_barrier
  s_barrier
  s_add_u32 s20, s4, 2490368
  s_addc_u32 s21, s5, 0
  s_mov_b32 s22, 147456
  s_mov_b32 s23, 0x20000
  v_mov_b32 v2, 0
  v_mov_b32 v3, 1
  s_mov_b64 exec, 1
  s_waitcnt vmcnt(0)
  buffer_atomic_add v3, v2, s[20:23], s52 offen sc1
  s_mov_b64 exec, -1
  s_branch K2_END
K2_EXTRA:
  s_load_dwordx2 s[6:7], s[0:1], 0
  s_load_dwordx2 s[40:41], s[0:1], 16
  s_load_dwordx4 s[44:47], s[0:1], 48
  s_setprio 3
  v_mov_b32 v4, 0
  v_mov_b32 v5, 153600
  ds_write_b32 v5, v4
  ds_write_b32 v5, v4 offset:4
  s_lshl_b32 s53, s36, 10
  s_add_u32 s53, s53, 36864
  s_waitcnt lgkmcnt(0)
  s_barrier
  s_mov_b32 m0, s53
  s_nop 0
  buffer_load_dwordx4 v2, s[8:11], s53 offen lds
  s_add_u32 s53, s53, 4096
  s_mov_b32 m0, s53
  s_nop 0
  buffer_load_dwordx4 v2, s[8:11], s53 offen lds
  s_add_u32 s53, s53, 4096
  s_mov_b32 m0, s53
  s_nop 0
  buffer_load_dwordx4 v2, s[8:11], s53 offen lds
  s_add_u32 s53, s53, 4096
  s_mov_b32 m0, s53
  s_nop 0
  buffer_load_dwordx4 v2, s[8:11], s53 offen lds
  s_add_u32 s53, s53, 4096
  s_mov_b32 m0, s53
  s_nop 0
  buffer_load_dwordx4 v2, s[8:11], s53 offen lds
  s_add_u32 s53, s53, 4096
  s_mov_b32 m0, s53
  s_nop 0
  buffer_load_dwordx4 v2, s[8:11], s53 offen lds
  s_add_u32 s53, s53, 4096
  s_mov_b32 m0, s53
  s_nop 0
  buffer_load_dwordx4 v2, s[8:11], s53 offen lds
  s_add_u32 s53, s53, 4096
  s_mov_b32 m0, s53
  s_nop 0
  buffer_load_dwordx4 v2, s[8:11], s53 offen lds
  s_add_u32 s53, s53, 4096
  s_mov_b32 m0, s53
  s_nop 0
  buffer_load_dwordx4 v2, s[8:11], s53 offen lds
  s_add_u32 s53, s53, 4096
  s_mov_b32 m0, s53
  s_nop 0
  buffer_load_dwordx4 v2, s[8:11], s53 offen lds
  s_add_u32 s53, s53, 4096
  s_mov_b32 m0, s53
  s_nop 0
  buffer_load_dwordx4 v2, s[8:11], s53 offen lds
  s_add_u32 s53, s53, 4096
  s_mov_b32 m0, s53
  s_nop 0
  buffer_load_dwordx4 v2, s[8:11], s53 offen lds
  s_add_u32 s53, s53, 4096
  s_mov_b32 m0, s53
  s_nop 0
  buffer_load_dwordx4 v2, s[8:11], s53 offen lds
  s_add_u32 s53, s53, 4096
  s_mov_b32 m0, s53
  s_nop 0
  buffer_load_dwordx4 v2, s[8:11], s53 offen lds
  s_add_u32 s53, s53, 4096
  s_mov_b32 m0, s53
  s_nop 0
  buffer_load_dwordx4 v2, s[8:11], s53 offen lds
  s_add_u32 s53, s53, 4096
  s_mov_b32 m0, s53
  s_nop 0
  buffer_load_dwordx4 v2, s[8:11], s53 offen lds
  s_add_u32 s53, s53, 4096
  s_mov_b32 m0, s53
  s_nop 0
  buffer_load_dwordx4 v2, s[8:11], s53 offen lds
  s_add_u32 s53, s53, 4096
  s_mov_b32 m0, s53
  s_nop 0
  buffer_load_dwordx4 v2, s[8:11], s53 offen lds
  s_add_u32 s53, s53, 4096
  s_mov_b32 m0, s53
  s_nop 0
  buffer_load_dwordx4 v2, s[8:11], s53 offen lds
  s_add_u32 s53, s53, 4096
  s_mov_b32 m0, s53
  s_nop 0
  buffer_load_dwordx4 v2, s[8:11], s53 offen lds
  s_add_u32 s53, s53, 4096
  s_mov_b32 m0, s53
  s_nop 0
  buffer_load_dwordx4 v2, s[8:11], s53 offen lds
  s_add_u32 s53, s53, 4096
  s_mov_b32 m0, s53
  s_nop 0
  buffer_load_dwordx4 v2, s[8:11], s53 offen lds
  s_add_u32 s53, s53, 4096
  s_mov_b32 m0, s53
  s_nop 0
  buffer_load_dwordx4 v2, s[8:11], s53 offen lds
  s_add_u32 s53, s53, 4096
  s_mov_b32 m0, s53
  s_nop 0
  buffer_load_dwordx4 v2, s[8:11], s53 offen lds
  s_add_u32 s53, s53, 4096
  s_mov_b32 m0, s53
  s_nop 0
  buffer_load_dwordx4 v2, s[8:11], s53 offen lds
  s_add_u32 s53, s53, 4096
  s_mov_b32 m0, s53
  s_nop 0
  buffer_load_dwordx4 v2, s[8:11], s53 offen lds
  s_add_u32 s53, s53, 4096
  s_mov_b32 m0, s53
  s_nop 0
  buffer_load_dwordx4 v2, s[8:11], s53 offen lds
  s_add_u32 s53, s53, 4096
  s_sub_u32 s37, s36, 4
  s_and_b32 s39, s37, 1
  s_lshl_b32 s39, s39, 8
  s_add_u32 s39, s39, s2
  s_cmp_ge_u32 s37, 2
  s_cbranch_scc1 K2_REPACK
  s_movk_i32 s39, 432
  s_sub_u32 s37, s36, 4
  s_and_b32 s52, s50, 1
  s_lshl_b32 s52, s52, 6
  s_lshr_b32 s53, s50, 1
  s_lshl_b32 s53, s53, 4
  s_add_u32 s52, s52, s53
  s_lshr_b32 s53, s2, 4
  s_add_u32 s38, s52, s53
  s_and_b32 s57, s51, 1
  s_lshl_b32 s57, s57, 1
  s_add_u32 s57, s57, s37
  s_mul_i32 s58, s57, 9
  s_mov_b32 s59, 1.0
  v_and_b32 v2, 15, v1
  v_lshrrev_b32 v3, 4, v1
  s_lshl_b32 s52, s38, 4
  v_add_u32 v244, s52, v2
  v_add_u32 v244, -1, v244
  v_ashrrev_i32 v245, 4, v244
  v_mul_i32_i24 v245, 18432, v245
  v_and_b32 v244, 15, v244
  v_lshl_add_u32 v244, v244, 4, v245
  v_lshl_add_u32 v244, v3, 8, v244
  v_add_u32 v240, 0, v244
  v_add_u32 v244, s52, v2
  v_add_u32 v244, 1, v244
  v_ashrrev_i32 v245, 4, v244
  v_mul_i32_i24 v245, 18432, v245
  v_and_b32 v244, 15, v244
  v_lshl_add_u32 v244, v244, 4, v245
  v_lshl_add_u32 v244, v3, 8, v244
  v_add_u32 v241, 4096, v244
  v_add_u32 v244, s52, v2
  v_add_u32 v244, -2, v244
  v_ashrrev_i32 v245, 4, v244
  v_mul_i32_i24 v245, 18432, v245
  v_and_b32 v244, 15, v244
  v_lshl_add_u32 v244, v244, 4, v245
  v_lshl_add_u32 v244, v3, 8, v244
  v_add_u32 v242, 8192, v244
  v_add_u32 v244, s52, v2
  v_add_u32 v244, 2, v244
  v_ashrrev_i32 v245, 4, v244
  v_mul_i32_i24 v245, 18432, v245
  v_and_b32 v244, 15, v244
  v_lshl_add_u32 v244, v244, 4, v245
  v_lshl_add_u32 v244, v3, 8, v244
  v_add_u32 v243, 12288, v244
  s_add_u32 s8, s4, 8388608
  s_addc_u32 s9, s5, 0
  s_mov_b32 s10, 2359296
  s_mov_b32 s11, 0x20000
  s_add_u32 s12, s4, 11534336
  s_addc_u32 s13, s5, 0
  s_mov_b32 s14, 663552
  s_mov_b32 s15, 0x20000
  s_mov_b32 s16, s6
  s_mov_b32 s17, s7
  s_mov_b32 s18, 2359296
  s_mov_b32 s19, 0x20000
  s_add_u32 s20, s4, 2424832
  s_addc_u32 s21, s5, 0
  s_mov_b32 s22, 16384
  s_mov_b32 s23, 0x20000
  s_mul_i32 s55, s38, 18432
  s_lshl_b32 s54, s58, 5
  s_add_u32 s55, s55, s54
  v_lshlrev_b32 v245, 3, v2
  s_lshl_b32 s54, s38, 7
  v_lshlrev_b32 v244, 4, v1
  v_add_u32 v248, 4096, v244
  v_add_u32 v249, 8192, v244
  s_lshl_b32 s53, s58, 10
  v_cmp_gt_u32 vcc, 32, v1
  buffer_load_dwordx4 v[40:43], v240, s[8:11], 0 offen offset:0
  buffer_load_dwordx4 v[4:7], v244, s[12:15], s53 offen offset:0
  buffer_load_dwordx4 v[8:11], v244, s[12:15], s53 offen offset:1024
  buffer_load_dwordx4 v[12:15], v244, s[12:15], s53 offen offset:2048
  buffer_load_dwordx4 v[16:19], v244, s[12:15], s53 offen offset:3072
  buffer_load_dwordx4 v[20:23], v248, s[12:15], s53 offen offset:0
  buffer_load_dwordx4 v[24:27], v248, s[12:15], s53 offen offset:1024
  buffer_load_dwordx4 v[28:31], v248, s[12:15], s53 offen offset:2048
  buffer_load_dwordx4 v[32:35], v248, s[12:15], s53 offen offset:3072
  buffer_load_dwordx4 v[36:39], v249, s[12:15], s53 offen offset:0
  s_add_u32 s53, s53, 36864
  s_waitcnt vmcnt(10)
  s_barrier
  buffer_load_dwordx4 v[80:83], v240, s[8:11], 0 offen offset:1024
  buffer_load_dwordx4 v[44:47], v244, s[12:15], s53 offen offset:0
  buffer_load_dwordx4 v[48:51], v244, s[12:15], s53 offen offset:1024
  buffer_load_dwordx4 v[52:55], v244, s[12:15], s53 offen offset:2048
  buffer_load_dwordx4 v[56:59], v244, s[12:15], s53 offen offset:3072
  buffer_load_dwordx4 v[60:63], v248, s[12:15], s53 offen offset:0
  buffer_load_dwordx4 v[64:67], v248, s[12:15], s53 offen offset:1024
  buffer_load_dwordx4 v[68:71], v248, s[12:15], s53 offen offset:2048
  buffer_load_dwordx4 v[72:75], v248, s[12:15], s53 offen offset:3072
  buffer_load_dwordx4 v[76:79], v249, s[12:15], s53 offen offset:0
  s_add_u32 s53, s53, 36864
  buffer_load_dwordx4 v[120:123], v240, s[8:11], 0 offen offset:2048
  buffer_load_dwordx4 v[84:87], v244, s[12:15], s53 offen offset:0
  buffer_load_dwordx4 v[88:91], v244, s[12:15], s53 offen offset:1024
  buffer_load_dwordx4 v[92:95], v244, s[12:15], s53 offen offset:2048
  buffer_load_dwordx4 v[96:99], v244, s[12:15], s53 offen offset:3072
  buffer_load_dwordx4 v[100:103], v248, s[12:15], s53 offen offset:0
  buffer_load_dwordx4 v[104:107], v248, s[12:15], s53 offen offset:1024
  buffer_load_dwordx4 v[108:111], v248, s[12:15], s53 offen offset:2048
  buffer_load_dwordx4 v[112:115], v248, s[12:15], s53 offen offset:3072
  buffer_load_dwordx4 v[116:119], v249, s[12:15], s53 offen offset:0
  s_add_u32 s53, s53, 36864
  buffer_load_dwordx4 v[160:163], v240, s[8:11], 0 offen offset:3072
  buffer_load_dwordx4 v[124:127], v244, s[12:15], s53 offen offset:0
  buffer_load_dwordx4 v[128:131], v244, s[12:15], s53 offen offset:1024
  buffer_load_dwordx4 v[132:135], v244, s[12:15], s53 offen offset:2048
  buffer_load_dwordx4 v[136:139], v244, s[12:15], s53 offen offset:3072
  buffer_load_dwordx4 v[140:143], v248, s[12:15], s53 offen offset:0
  buffer_load_dwordx4 v[144:147], v248, s[12:15], s53 offen offset:1024
  buffer_load_dwordx4 v[148:151], v248, s[12:15], s53 offen offset:2048
  buffer_load_dwordx4 v[152:155], v248, s[12:15], s53 offen offset:3072
  buffer_load_dwordx4 v[156:159], v249, s[12:15], s53 offen offset:0
  s_add_u32 s53, s53, 36864
  buffer_load_dwordx4 v[200:203], v241, s[8:11], 0 offen offset:0
  buffer_load_dwordx4 v[164:167], v244, s[12:15], s53 offen offset:0
  buffer_load_dwordx4 v[168:171], v244, s[12:15], s53 offen offset:1024
  buffer_load_dwordx4 v[172:175], v244, s[12:15], s53 offen offset:2048
  buffer_load_dwordx4 v[176:179], v244, s[12:15], s53 offen offset:3072
  buffer_load_dwordx4 v[180:183], v248, s[12:15], s53 offen offset:0
  buffer_load_dwordx4 v[184:187], v248, s[12:15], s53 offen offset:1024
  buffer_load_dwordx4 v[188:191], v248, s[12:15], s53 offen offset:2048
  buffer_load_dwordx4 v[192:195], v248, s[12:15], s53 offen offset:3072
  buffer_load_dwordx4 v[196:199], v249, s[12:15], s53 offen offset:0
  s_add_u32 s53, s53, 36864
  buffer_load_dwordx2 v[246:247], v245, s[20:23], s54 offen
  s_waitcnt vmcnt(41)
  v_mfma_f32_16x16x32_bf16 v[204:207], v[4:7], v[40:43], 0
  v_mfma_f32_16x16x32_bf16 v[208:211], v[8:11], v[40:43], 0
  v_mfma_f32_16x16x32_bf16 v[212:215], v[12:15], v[40:43], 0
  v_mfma_f32_16x16x32_bf16 v[216:219], v[16:19], v[40:43], 0
  v_mfma_f32_16x16x32_bf16 v[220:223], v[20:23], v[40:43], 0
  v_mfma_f32_16x16x32_bf16 v[224:227], v[24:27], v[40:43], 0
  v_mfma_f32_16x16x32_bf16 v[228:231], v[28:31], v[40:43], 0
  v_mfma_f32_16x16x32_bf16 v[232:235], v[32:35], v[40:43], 0
  v_mfma_f32_16x16x32_bf16 v[236:239], v[36:39], v[40:43], 0
  buffer_load_dwordx4 v[40:43], v241, s[8:11], 0 offen offset:1024
  buffer_load_dwordx4 v[4:7], v244, s[12:15], s53 offen offset:0
  buffer_load_dwordx4 v[8:11], v244, s[12:15], s53 offen offset:1024
  buffer_load_dwordx4 v[12:15], v244, s[12:15], s53 offen offset:2048
  buffer_load_dwordx4 v[16:19], v244, s[12:15], s53 offen offset:3072
  buffer_load_dwordx4 v[20:23], v248, s[12:15], s53 offen offset:0
  buffer_load_dwordx4 v[24:27], v248, s[12:15], s53 offen offset:1024
  buffer_load_dwordx4 v[28:31], v248, s[12:15], s53 offen offset:2048
  buffer_load_dwordx4 v[32:35], v248, s[12:15], s53 offen offset:3072
  buffer_load_dwordx4 v[36:39], v249, s[12:15], s53 offen offset:0
  s_add_u32 s53, s53, 36864
  s_waitcnt vmcnt(41)
  v_mfma_f32_16x16x32_bf16 v[204:207], v[44:47], v[80:83], v[204:207]
  v_mfma_f32_16x16x32_bf16 v[208:211], v[48:51], v[80:83], v[208:211]
  v_mfma_f32_16x16x32_bf16 v[212:215], v[52:55], v[80:83], v[212:215]
  v_mfma_f32_16x16x32_bf16 v[216:219], v[56:59], v[80:83], v[216:219]
  v_mfma_f32_16x16x32_bf16 v[220:223], v[60:63], v[80:83], v[220:223]
  v_mfma_f32_16x16x32_bf16 v[224:227], v[64:67], v[80:83], v[224:227]
  v_mfma_f32_16x16x32_bf16 v[228:231], v[68:71], v[80:83], v[228:231]
  v_mfma_f32_16x16x32_bf16 v[232:235], v[72:75], v[80:83], v[232:235]
  v_mfma_f32_16x16x32_bf16 v[236:239], v[76:79], v[80:83], v[236:239]
  buffer_load_dwordx4 v[80:83], v241, s[8:11], 0 offen offset:2048
  buffer_load_dwordx4 v[44:47], v244, s[12:15], s53 offen offset:0
  buffer_load_dwordx4 v[48:51], v244, s[12:15], s53 offen offset:1024
  buffer_load_dwordx4 v[52:55], v244, s[12:15], s53 offen offset:2048
  buffer_load_dwordx4 v[56:59], v244, s[12:15], s53 offen offset:3072
  buffer_load_dwordx4 v[60:63], v248, s[12:15], s53 offen offset:0
  buffer_load_dwordx4 v[64:67], v248, s[12:15], s53 offen offset:1024
  buffer_load_dwordx4 v[68:71], v248, s[12:15], s53 offen offset:2048
  buffer_load_dwordx4 v[72:75], v248, s[12:15], s53 offen offset:3072
  buffer_load_dwordx4 v[76:79], v249, s[12:15], s53 offen offset:0
  s_add_u32 s53, s53, 36864
  s_waitcnt vmcnt(41)
  v_mfma_f32_16x16x32_bf16 v[204:207], v[84:87], v[120:123], v[204:207]
  v_mfma_f32_16x16x32_bf16 v[208:211], v[88:91], v[120:123], v[208:211]
  v_mfma_f32_16x16x32_bf16 v[212:215], v[92:95], v[120:123], v[212:215]
  v_mfma_f32_16x16x32_bf16 v[216:219], v[96:99], v[120:123], v[216:219]
  v_mfma_f32_16x16x32_bf16 v[220:223], v[100:103], v[120:123], v[220:223]
  v_mfma_f32_16x16x32_bf16 v[224:227], v[104:107], v[120:123], v[224:227]
  v_mfma_f32_16x16x32_bf16 v[228:231], v[108:111], v[120:123], v[228:231]
  v_mfma_f32_16x16x32_bf16 v[232:235], v[112:115], v[120:123], v[232:235]
  v_mfma_f32_16x16x32_bf16 v[236:239], v[116:119], v[120:123], v[236:239]
  buffer_load_dwordx4 v[120:123], v241, s[8:11], 0 offen offset:3072
  buffer_load_dwordx4 v[84:87], v244, s[12:15], s53 offen offset:0
  buffer_load_dwordx4 v[88:91], v244, s[12:15], s53 offen offset:1024
  buffer_load_dwordx4 v[92:95], v244, s[12:15], s53 offen offset:2048
  buffer_load_dwordx4 v[96:99], v244, s[12:15], s53 offen offset:3072
  buffer_load_dwordx4 v[100:103], v248, s[12:15], s53 offen offset:0
  buffer_load_dwordx4 v[104:107], v248, s[12:15], s53 offen offset:1024
  buffer_load_dwordx4 v[108:111], v248, s[12:15], s53 offen offset:2048
  buffer_load_dwordx4 v[112:115], v248, s[12:15], s53 offen offset:3072
  buffer_load_dwordx4 v[116:119], v249, s[12:15], s53 offen offset:0
  s_add_u32 s53, s53, 36864
  s_waitcnt vmcnt(41)
  v_mfma_f32_16x16x32_bf16 v[204:207], v[124:127], v[160:163], v[204:207]
  v_mfma_f32_16x16x32_bf16 v[208:211], v[128:131], v[160:163], v[208:211]
  v_mfma_f32_16x16x32_bf16 v[212:215], v[132:135], v[160:163], v[212:215]
  v_mfma_f32_16x16x32_bf16 v[216:219], v[136:139], v[160:163], v[216:219]
  v_mfma_f32_16x16x32_bf16 v[220:223], v[140:143], v[160:163], v[220:223]
  v_mfma_f32_16x16x32_bf16 v[224:227], v[144:147], v[160:163], v[224:227]
  v_mfma_f32_16x16x32_bf16 v[228:231], v[148:151], v[160:163], v[228:231]
  v_mfma_f32_16x16x32_bf16 v[232:235], v[152:155], v[160:163], v[232:235]
  v_mfma_f32_16x16x32_bf16 v[236:239], v[156:159], v[160:163], v[236:239]
  buffer_load_dwordx4 v[160:163], v242, s[8:11], 0 offen offset:0
  buffer_load_dwordx4 v[124:127], v244, s[12:15], s53 offen offset:0
  buffer_load_dwordx4 v[128:131], v244, s[12:15], s53 offen offset:1024
  buffer_load_dwordx4 v[132:135], v244, s[12:15], s53 offen offset:2048
  buffer_load_dwordx4 v[136:139], v244, s[12:15], s53 offen offset:3072
  buffer_load_dwordx4 v[140:143], v248, s[12:15], s53 offen offset:0
  buffer_load_dwordx4 v[144:147], v248, s[12:15], s53 offen offset:1024
  buffer_load_dwordx4 v[148:151], v248, s[12:15], s53 offen offset:2048
  buffer_load_dwordx4 v[152:155], v248, s[12:15], s53 offen offset:3072
  buffer_load_dwordx4 v[156:159], v249, s[12:15], s53 offen offset:0
  s_add_u32 s53, s53, 36864
  s_waitcnt vmcnt(41)
  v_mfma_f32_16x16x32_bf16 v[204:207], v[164:167], v[200:203], v[204:207]
  v_mfma_f32_16x16x32_bf16 v[208:211], v[168:171], v[200:203], v[208:211]
  v_mfma_f32_16x16x32_bf16 v[212:215], v[172:175], v[200:203], v[212:215]
  v_mfma_f32_16x16x32_bf16 v[216:219], v[176:179], v[200:203], v[216:219]
  v_mfma_f32_16x16x32_bf16 v[220:223], v[180:183], v[200:203], v[220:223]
  v_mfma_f32_16x16x32_bf16 v[224:227], v[184:187], v[200:203], v[224:227]
  v_mfma_f32_16x16x32_bf16 v[228:231], v[188:191], v[200:203], v[228:231]
  v_mfma_f32_16x16x32_bf16 v[232:235], v[192:195], v[200:203], v[232:235]
  v_mfma_f32_16x16x32_bf16 v[236:239], v[196:199], v[200:203], v[236:239]
  buffer_load_dwordx4 v[200:203], v242, s[8:11], 0 offen offset:1024
  buffer_load_dwordx4 v[164:167], v244, s[12:15], s53 offen offset:0
  buffer_load_dwordx4 v[168:171], v244, s[12:15], s53 offen offset:1024
  buffer_load_dwordx4 v[172:175], v244, s[12:15], s53 offen offset:2048
  buffer_load_dwordx4 v[176:179], v244, s[12:15], s53 offen offset:3072
  buffer_load_dwordx4 v[180:183], v248, s[12:15], s53 offen offset:0
  buffer_load_dwordx4 v[184:187], v248, s[12:15], s53 offen offset:1024
  buffer_load_dwordx4 v[188:191], v248, s[12:15], s53 offen offset:2048
  buffer_load_dwordx4 v[192:195], v248, s[12:15], s53 offen offset:3072
  buffer_load_dwordx4 v[196:199], v249, s[12:15], s53 offen offset:0
  s_add_u32 s53, s53, 36864
  s_waitcnt vmcnt(40)
  v_mfma_f32_16x16x32_bf16 v[204:207], v[4:7], v[40:43], v[204:207]
  v_mfma_f32_16x16x32_bf16 v[208:211], v[8:11], v[40:43], v[208:211]
  v_mfma_f32_16x16x32_bf16 v[212:215], v[12:15], v[40:43], v[212:215]
  v_mfma_f32_16x16x32_bf16 v[216:219], v[16:19], v[40:43], v[216:219]
  v_mfma_f32_16x16x32_bf16 v[220:223], v[20:23], v[40:43], v[220:223]
  v_mfma_f32_16x16x32_bf16 v[224:227], v[24:27], v[40:43], v[224:227]
  v_mfma_f32_16x16x32_bf16 v[228:231], v[28:31], v[40:43], v[228:231]
  v_mfma_f32_16x16x32_bf16 v[232:235], v[32:35], v[40:43], v[232:235]
  v_mfma_f32_16x16x32_bf16 v[236:239], v[36:39], v[40:43], v[236:239]
  buffer_load_dwordx4 v[40:43], v242, s[8:11], 0 offen offset:2048
  buffer_load_dwordx4 v[4:7], v244, s[12:15], s53 offen offset:0
  buffer_load_dwordx4 v[8:11], v244, s[12:15], s53 offen offset:1024
  buffer_load_dwordx4 v[12:15], v244, s[12:15], s53 offen offset:2048
  buffer_load_dwordx4 v[16:19], v244, s[12:15], s53 offen offset:3072
  buffer_load_dwordx4 v[20:23], v248, s[12:15], s53 offen offset:0
  buffer_load_dwordx4 v[24:27], v248, s[12:15], s53 offen offset:1024
  buffer_load_dwordx4 v[28:31], v248, s[12:15], s53 offen offset:2048
  buffer_load_dwordx4 v[32:35], v248, s[12:15], s53 offen offset:3072
  buffer_load_dwordx4 v[36:39], v249, s[12:15], s53 offen offset:0
  s_add_u32 s53, s53, 36864
  s_waitcnt vmcnt(40)
  v_mfma_f32_16x16x32_bf16 v[204:207], v[44:47], v[80:83], v[204:207]
  v_mfma_f32_16x16x32_bf16 v[208:211], v[48:51], v[80:83], v[208:211]
  v_mfma_f32_16x16x32_bf16 v[212:215], v[52:55], v[80:83], v[212:215]
  v_mfma_f32_16x16x32_bf16 v[216:219], v[56:59], v[80:83], v[216:219]
  v_mfma_f32_16x16x32_bf16 v[220:223], v[60:63], v[80:83], v[220:223]
  v_mfma_f32_16x16x32_bf16 v[224:227], v[64:67], v[80:83], v[224:227]
  v_mfma_f32_16x16x32_bf16 v[228:231], v[68:71], v[80:83], v[228:231]
  v_mfma_f32_16x16x32_bf16 v[232:235], v[72:75], v[80:83], v[232:235]
  v_mfma_f32_16x16x32_bf16 v[236:239], v[76:79], v[80:83], v[236:239]
  buffer_load_dwordx4 v[80:83], v242, s[8:11], 0 offen offset:3072
  buffer_load_dwordx4 v[44:47], v244, s[12:15], s53 offen offset:0
  buffer_load_dwordx4 v[48:51], v244, s[12:15], s53 offen offset:1024
  buffer_load_dwordx4 v[52:55], v244, s[12:15], s53 offen offset:2048
  buffer_load_dwordx4 v[56:59], v244, s[12:15], s53 offen offset:3072
  buffer_load_dwordx4 v[60:63], v248, s[12:15], s53 offen offset:0
  buffer_load_dwordx4 v[64:67], v248, s[12:15], s53 offen offset:1024
  buffer_load_dwordx4 v[68:71], v248, s[12:15], s53 offen offset:2048
  buffer_load_dwordx4 v[72:75], v248, s[12:15], s53 offen offset:3072
  buffer_load_dwordx4 v[76:79], v249, s[12:15], s53 offen offset:0
  s_add_u32 s53, s53, 36864
  s_waitcnt vmcnt(40)
  v_mfma_f32_16x16x32_bf16 v[204:207], v[84:87], v[120:123], v[204:207]
  v_mfma_f32_16x16x32_bf16 v[208:211], v[88:91], v[120:123], v[208:211]
  v_mfma_f32_16x16x32_bf16 v[212:215], v[92:95], v[120:123], v[212:215]
  v_mfma_f32_16x16x32_bf16 v[216:219], v[96:99], v[120:123], v[216:219]
  v_mfma_f32_16x16x32_bf16 v[220:223], v[100:103], v[120:123], v[220:223]
  v_mfma_f32_16x16x32_bf16 v[224:227], v[104:107], v[120:123], v[224:227]
  v_mfma_f32_16x16x32_bf16 v[228:231], v[108:111], v[120:123], v[228:231]
  v_mfma_f32_16x16x32_bf16 v[232:235], v[112:115], v[120:123], v[232:235]
  v_mfma_f32_16x16x32_bf16 v[236:239], v[116:119], v[120:123], v[236:239]
  buffer_load_dwordx4 v[120:123], v243, s[8:11], 0 offen offset:0
  buffer_load_dwordx4 v[84:87], v244, s[12:15], s53 offen offset:0
  buffer_load_dwordx4 v[88:91], v244, s[12:15], s53 offen offset:1024
  buffer_load_dwordx4 v[92:95], v244, s[12:15], s53 offen offset:2048
  buffer_load_dwordx4 v[96:99], v244, s[12:15], s53 offen offset:3072
  buffer_load_dwordx4 v[100:103], v248, s[12:15], s53 offen offset:0
  buffer_load_dwordx4 v[104:107], v248, s[12:15], s53 offen offset:1024
  buffer_load_dwordx4 v[108:111], v248, s[12:15], s53 offen offset:2048
  buffer_load_dwordx4 v[112:115], v248, s[12:15], s53 offen offset:3072
  buffer_load_dwordx4 v[116:119], v249, s[12:15], s53 offen offset:0
  s_add_u32 s53, s53, 36864
  s_waitcnt vmcnt(40)
  v_mfma_f32_16x16x32_bf16 v[204:207], v[124:127], v[160:163], v[204:207]
  v_mfma_f32_16x16x32_bf16 v[208:211], v[128:131], v[160:163], v[208:211]
  v_mfma_f32_16x16x32_bf16 v[212:215], v[132:135], v[160:163], v[212:215]
  v_mfma_f32_16x16x32_bf16 v[216:219], v[136:139], v[160:163], v[216:219]
  v_mfma_f32_16x16x32_bf16 v[220:223], v[140:143], v[160:163], v[220:223]
  v_mfma_f32_16x16x32_bf16 v[224:227], v[144:147], v[160:163], v[224:227]
  v_mfma_f32_16x16x32_bf16 v[228:231], v[148:151], v[160:163], v[228:231]
  v_mfma_f32_16x16x32_bf16 v[232:235], v[152:155], v[160:163], v[232:235]
  v_mfma_f32_16x16x32_bf16 v[236:239], v[156:159], v[160:163], v[236:239]
  buffer_load_dwordx4 v[160:163], v243, s[8:11], 0 offen offset:1024
  buffer_load_dwordx4 v[124:127], v244, s[12:15], s53 offen offset:0
  buffer_load_dwordx4 v[128:131], v244, s[12:15], s53 offen offset:1024
  buffer_load_dwordx4 v[132:135], v244, s[12:15], s53 offen offset:2048
  buffer_load_dwordx4 v[136:139], v244, s[12:15], s53 offen offset:3072
  buffer_load_dwordx4 v[140:143], v248, s[12:15], s53 offen offset:0
  buffer_load_dwordx4 v[144:147], v248, s[12:15], s53 offen offset:1024
  buffer_load_dwordx4 v[148:151], v248, s[12:15], s53 offen offset:2048
  buffer_load_dwordx4 v[152:155], v248, s[12:15], s53 offen offset:3072
  buffer_load_dwordx4 v[156:159], v249, s[12:15], s53 offen offset:0
  s_add_u32 s53, s53, 36864
  s_waitcnt vmcnt(40)
  v_mfma_f32_16x16x32_bf16 v[204:207], v[164:167], v[200:203], v[204:207]
  v_mfma_f32_16x16x32_bf16 v[208:211], v[168:171], v[200:203], v[208:211]
  v_mfma_f32_16x16x32_bf16 v[212:215], v[172:175], v[200:203], v[212:215]
  v_mfma_f32_16x16x32_bf16 v[216:219], v[176:179], v[200:203], v[216:219]
  v_mfma_f32_16x16x32_bf16 v[220:223], v[180:183], v[200:203], v[220:223]
  v_mfma_f32_16x16x32_bf16 v[224:227], v[184:187], v[200:203], v[224:227]
  v_mfma_f32_16x16x32_bf16 v[228:231], v[188:191], v[200:203], v[228:231]
  v_mfma_f32_16x16x32_bf16 v[232:235], v[192:195], v[200:203], v[232:235]
  v_mfma_f32_16x16x32_bf16 v[236:239], v[196:199], v[200:203], v[236:239]
  buffer_load_dwordx4 v[200:203], v243, s[8:11], 0 offen offset:2048
  buffer_load_dwordx4 v[164:167], v244, s[12:15], s53 offen offset:0
  buffer_load_dwordx4 v[168:171], v244, s[12:15], s53 offen offset:1024
  buffer_load_dwordx4 v[172:175], v244, s[12:15], s53 offen offset:2048
  buffer_load_dwordx4 v[176:179], v244, s[12:15], s53 offen offset:3072
  buffer_load_dwordx4 v[180:183], v248, s[12:15], s53 offen offset:0
  buffer_load_dwordx4 v[184:187], v248, s[12:15], s53 offen offset:1024
  buffer_load_dwordx4 v[188:191], v248, s[12:15], s53 offen offset:2048
  buffer_load_dwordx4 v[192:195], v248, s[12:15], s53 offen offset:3072
  buffer_load_dwordx4 v[196:199], v249, s[12:15], s53 offen offset:0
  s_add_u32 s53, s53, 36864
  s_waitcnt vmcnt(40)
  v_mfma_f32_16x16x32_bf16 v[204:207], v[4:7], v[40:43], v[204:207]
  v_mfma_f32_16x16x32_bf16 v[208:211], v[8:11], v[40:43], v[208:211]
  v_mfma_f32_16x16x32_bf16 v[212:215], v[12:15], v[40:43], v[212:215]
  v_mfma_f32_16x16x32_bf16 v[216:219], v[16:19], v[40:43], v[216:219]
  v_mfma_f32_16x16x32_bf16 v[220:223], v[20:23], v[40:43], v[220:223]
  v_mfma_f32_16x16x32_bf16 v[224:227], v[24:27], v[40:43], v[224:227]
  v_mfma_f32_16x16x32_bf16 v[228:231], v[28:31], v[40:43], v[228:231]
  v_mfma_f32_16x16x32_bf16 v[232:235], v[32:35], v[40:43], v[232:235]
  v_mfma_f32_16x16x32_bf16 v[236:239], v[36:39], v[40:43], v[236:239]
  buffer_load_dwordx4 v[40:43], v243, s[8:11], 0 offen offset:3072
  buffer_load_dwordx4 v[4:7], v244, s[12:15], s53 offen offset:0
  buffer_load_dwordx4 v[8:11], v244, s[12:15], s53 offen offset:1024
  buffer_load_dwordx4 v[12:15], v244, s[12:15], s53 offen offset:2048
  buffer_load_dwordx4 v[16:19], v244, s[12:15], s53 offen offset:3072
  buffer_load_dwordx4 v[20:23], v248, s[12:15], s53 offen offset:0
  buffer_load_dwordx4 v[24:27], v248, s[12:15], s53 offen offset:1024
  buffer_load_dwordx4 v[28:31], v248, s[12:15], s53 offen offset:2048
  buffer_load_dwordx4 v[32:35], v248, s[12:15], s53 offen offset:3072
  buffer_load_dwordx4 v[36:39], v249, s[12:15], s53 offen offset:0
  s_add_u32 s53, s53, 36864
  s_waitcnt vmcnt(40)
  v_mfma_f32_16x16x32_bf16 v[204:207], v[44:47], v[80:83], v[204:207]
  v_mfma_f32_16x16x32_bf16 v[208:211], v[48:51], v[80:83], v[208:211]
  v_mfma_f32_16x16x32_bf16 v[212:215], v[52:55], v[80:83], v[212:215]
  v_mfma_f32_16x16x32_bf16 v[216:219], v[56:59], v[80:83], v[216:219]
  v_mfma_f32_16x16x32_bf16 v[220:223], v[60:63], v[80:83], v[220:223]
  v_mfma_f32_16x16x32_bf16 v[224:227], v[64:67], v[80:83], v[224:227]
  v_mfma_f32_16x16x32_bf16 v[228:231], v[68:71], v[80:83], v[228:231]
  v_mfma_f32_16x16x32_bf16 v[232:235], v[72:75], v[80:83], v[232:235]
  v_mfma_f32_16x16x32_bf16 v[236:239], v[76:79], v[80:83], v[236:239]
  v_add_u32 v241, -4096, v241
  v_cndmask_b32 v240, v241, v240, vcc
  s_mov_b32 s56, 16384
  buffer_load_dwordx4 v[80:83], v240, s[8:11], s56 offen
  buffer_load_dwordx4 v[44:47], v244, s[12:15], s53 offen offset:0
  buffer_load_dwordx4 v[48:51], v244, s[12:15], s53 offen offset:1024
  buffer_load_dwordx4 v[52:55], v244, s[12:15], s53 offen offset:2048
  buffer_load_dwordx4 v[56:59], v244, s[12:15], s53 offen offset:3072
  buffer_load_dwordx4 v[60:63], v248, s[12:15], s53 offen offset:0
  buffer_load_dwordx4 v[64:67], v248, s[12:15], s53 offen offset:1024
  buffer_load_dwordx4 v[68:71], v248, s[12:15], s53 offen offset:2048
  buffer_load_dwordx4 v[72:75], v248, s[12:15], s53 offen offset:3072
  buffer_load_dwordx4 v[76:79], v249, s[12:15], s53 offen offset:0
  s_add_u32 s53, s53, 36864
  s_waitcnt vmcnt(40)
  v_mfma_f32_16x16x32_bf16 v[204:207], v[84:87], v[120:123], v[204:207]
  v_mfma_f32_16x16x32_bf16 v[208:211], v[88:91], v[120:123], v[208:211]
  v_mfma_f32_16x16x32_bf16 v[212:215], v[92:95], v[120:123], v[212:215]
  v_mfma_f32_16x16x32_bf16 v[216:219], v[96:99], v[120:123], v[216:219]
  v_mfma_f32_16x16x32_bf16 v[220:223], v[100:103], v[120:123], v[220:223]
  v_mfma_f32_16x16x32_bf16 v[224:227], v[104:107], v[120:123], v[224:227]
  v_mfma_f32_16x16x32_bf16 v[228:231], v[108:111], v[120:123], v[228:231]
  v_mfma_f32_16x16x32_bf16 v[232:235], v[112:115], v[120:123], v[232:235]
  v_mfma_f32_16x16x32_bf16 v[236:239], v[116:119], v[120:123], v[236:239]
  v_add_u32 v243, -4096, v243
  v_cndmask_b32 v242, v243, v242, vcc
  s_mov_b32 s56, 9216
  buffer_load_dwordx4 v[120:123], v242, s[8:11], s56 offen
  buffer_load_dwordx4 v[84:87], v244, s[12:15], s53 offen offset:0
  buffer_load_dwordx4 v[88:91], v244, s[12:15], s53 offen offset:1024
  buffer_load_dwordx4 v[92:95], v244, s[12:15], s53 offen offset:2048
  buffer_load_dwordx4 v[96:99], v244, s[12:15], s53 offen offset:3072
  buffer_load_dwordx4 v[100:103], v248, s[12:15], s53 offen offset:0
  buffer_load_dwordx4 v[104:107], v248, s[12:15], s53 offen offset:1024
  buffer_load_dwordx4 v[108:111], v248, s[12:15], s53 offen offset:2048
  buffer_load_dwordx4 v[112:115], v248, s[12:15], s53 offen offset:3072
  buffer_load_dwordx4 v[116:119], v249, s[12:15], s53 offen offset:0
  s_add_u32 s53, s53, 36864
  s_waitcnt vmcnt(40)
  v_mfma_f32_16x16x32_bf16 v[204:207], v[124:127], v[160:163], v[204:207]
  v_mfma_f32_16x16x32_bf16 v[208:211], v[128:131], v[160:163], v[208:211]
  v_mfma_f32_16x16x32_bf16 v[212:215], v[132:135], v[160:163], v[212:215]
  v_mfma_f32_16x16x32_bf16 v[216:219], v[136:139], v[160:163], v[216:219]
  v_mfma_f32_16x16x32_bf16 v[220:223], v[140:143], v[160:163], v[220:223]
  v_mfma_f32_16x16x32_bf16 v[224:227], v[144:147], v[160:163], v[224:227]
  v_mfma_f32_16x16x32_bf16 v[228:231], v[148:151], v[160:163], v[228:231]
  v_mfma_f32_16x16x32_bf16 v[232:235], v[152:155], v[160:163], v[232:235]
  v_mfma_f32_16x16x32_bf16 v[236:239], v[156:159], v[160:163], v[236:239]
  s_waitcnt vmcnt(30)
  v_mfma_f32_16x16x32_bf16 v[204:207], v[164:167], v[200:203], v[204:207]
  v_mfma_f32_16x16x32_bf16 v[208:211], v[168:171], v[200:203], v[208:211]
  v_mfma_f32_16x16x32_bf16 v[212:215], v[172:175], v[200:203], v[212:215]
  v_mfma_f32_16x16x32_bf16 v[216:219], v[176:179], v[200:203], v[216:219]
  v_mfma_f32_16x16x32_bf16 v[220:223], v[180:183], v[200:203], v[220:223]
  v_mfma_f32_16x16x32_bf16 v[224:227], v[184:187], v[200:203], v[224:227]
  v_mfma_f32_16x16x32_bf16 v[228:231], v[188:191], v[200:203], v[228:231]
  v_mfma_f32_16x16x32_bf16 v[232:235], v[192:195], v[200:203], v[232:235]
  v_mfma_f32_16x16x32_bf16 v[236:239], v[196:199], v[200:203], v[236:239]
  s_waitcnt vmcnt(20)
  v_mfma_f32_16x16x32_bf16 v[204:207], v[4:7], v[40:43], v[204:207]
  v_mfma_f32_16x16x32_bf16 v[208:211], v[8:11], v[40:43], v[208:211]
  v_mfma_f32_16x16x32_bf16 v[212:215], v[12:15], v[40:43], v[212:215]
  v_mfma_f32_16x16x32_bf16 v[216:219], v[16:19], v[40:43], v[216:219]
  v_mfma_f32_16x16x32_bf16 v[220:223], v[20:23], v[40:43], v[220:223]
  v_mfma_f32_16x16x32_bf16 v[224:227], v[24:27], v[40:43], v[224:227]
  v_mfma_f32_16x16x32_bf16 v[228:231], v[28:31], v[40:43], v[228:231]
  v_mfma_f32_16x16x32_bf16 v[232:235], v[32:35], v[40:43], v[232:235]
  v_mfma_f32_16x16x32_bf16 v[236:239], v[36:39], v[40:43], v[236:239]
  v_mul_u32_u24 v244, 1152, v2
  v_lshl_add_u32 v244, v3, 3, v244
  buffer_load_dwordx2 v[4:5], v244, s[16:19], s55 offen offset:0
  buffer_load_dwordx2 v[6:7], v244, s[16:19], s55 offen offset:32
  buffer_load_dwordx2 v[8:9], v244, s[16:19], s55 offen offset:64
  buffer_load_dwordx2 v[10:11], v244, s[16:19], s55 offen offset:96
  buffer_load_dwordx2 v[12:13], v244, s[16:19], s55 offen offset:128
  buffer_load_dwordx2 v[14:15], v244, s[16:19], s55 offen offset:160
  buffer_load_dwordx2 v[16:17], v244, s[16:19], s55 offen offset:192
  buffer_load_dwordx2 v[18:19], v244, s[16:19], s55 offen offset:224
  buffer_load_dwordx2 v[20:21], v244, s[16:19], s55 offen offset:256
  s_waitcnt vmcnt(19)
  v_mfma_f32_16x16x32_bf16 v[204:207], v[44:47], v[80:83], v[204:207]
  v_mfma_f32_16x16x32_bf16 v[208:211], v[48:51], v[80:83], v[208:211]
  v_mfma_f32_16x16x32_bf16 v[212:215], v[52:55], v[80:83], v[212:215]
  v_mfma_f32_16x16x32_bf16 v[216:219], v[56:59], v[80:83], v[216:219]
  v_mfma_f32_16x16x32_bf16 v[220:223], v[60:63], v[80:83], v[220:223]
  v_mfma_f32_16x16x32_bf16 v[224:227], v[64:67], v[80:83], v[224:227]
  v_mfma_f32_16x16x32_bf16 v[228:231], v[68:71], v[80:83], v[228:231]
  v_mfma_f32_16x16x32_bf16 v[232:235], v[72:75], v[80:83], v[232:235]
  v_mfma_f32_16x16x32_bf16 v[236:239], v[76:79], v[80:83], v[236:239]
  s_waitcnt vmcnt(9)
  v_mfma_f32_16x16x32_bf16 v[204:207], v[84:87], v[120:123], v[204:207]
  v_mfma_f32_16x16x32_bf16 v[208:211], v[88:91], v[120:123], v[208:211]
  v_mfma_f32_16x16x32_bf16 v[212:215], v[92:95], v[120:123], v[212:215]
  v_mfma_f32_16x16x32_bf16 v[216:219], v[96:99], v[120:123], v[216:219]
  v_mfma_f32_16x16x32_bf16 v[220:223], v[100:103], v[120:123], v[220:223]
  v_mfma_f32_16x16x32_bf16 v[224:227], v[104:107], v[120:123], v[224:227]
  v_mfma_f32_16x16x32_bf16 v[228:231], v[108:111], v[120:123], v[228:231]
  v_mfma_f32_16x16x32_bf16 v[232:235], v[112:115], v[120:123], v[232:235]
  v_mfma_f32_16x16x32_bf16 v[236:239], v[116:119], v[120:123], v[236:239]
  s_add_u32 s24, s4, 12582912
  s_addc_u32 s25, s5, 0
  s_mov_b32 s26, 2359296
  s_mov_b32 s27, 0x20000
  s_add_u32 s28, s4, 15728640
  s_addc_u32 s29, s5, 0
  s_mov_b32 s30, 2359296
  s_mov_b32 s31, 0x20000
  s_add_u32 s20, s4, 2506752
  s_addc_u32 s21, s5, 0
  s_mov_b32 s22, 131072
  s_mov_b32 s23, 0x20000
  s_waitcnt vmcnt(0)
  v_mul_f32 v242, -v246, v247
  v_mov_b32 v240, v247
  v_mov_b32 v246, s59
  v_lshlrev_b32 v48, 16, v4
  v_and_b32 v49, 0xffff0000, v4
  v_pk_fma_f32 v[204:205], v[48:49], v[240:241], v[204:205] op_sel_hi:[1,0,1]
  v_pk_add_f32 v[204:205], v[204:205], v[242:243] op_sel_hi:[1,0]
  v_pk_mul_f32 v[56:57], v[204:205], v[246:247] op_sel_hi:[1,0]
  v_pk_mul_f32 v[58:59], v[56:57], v[204:205]
  v_lshlrev_b32 v50, 16, v5
  v_and_b32 v51, 0xffff0000, v5
  v_pk_fma_f32 v[206:207], v[50:51], v[240:241], v[206:207] op_sel_hi:[1,0,1]
  v_pk_add_f32 v[206:207], v[206:207], v[242:243] op_sel_hi:[1,0]
  v_pk_mul_f32 v[50:51], v[206:207], v[246:247] op_sel_hi:[1,0]
  v_pk_add_f32 v[56:57], v[56:57], v[50:51]
  v_pk_fma_f32 v[58:59], v[50:51], v[206:207], v[58:59]
  v_lshlrev_b32 v52, 16, v6
  v_and_b32 v53, 0xffff0000, v6
  v_pk_fma_f32 v[208:209], v[52:53], v[240:241], v[208:209] op_sel_hi:[1,0,1]
  v_pk_add_f32 v[208:209], v[208:209], v[242:243] op_sel_hi:[1,0]
  v_pk_add_f32 v[56:57], v[56:57], v[208:209]
  v_pk_fma_f32 v[58:59], v[208:209], v[208:209], v[58:59]
  v_lshlrev_b32 v54, 16, v7
  v_and_b32 v55, 0xffff0000, v7
  v_pk_fma_f32 v[210:211], v[54:55], v[240:241], v[210:211] op_sel_hi:[1,0,1]
  v_pk_add_f32 v[210:211], v[210:211], v[242:243] op_sel_hi:[1,0]
  v_pk_add_f32 v[56:57], v[56:57], v[210:211]
  v_pk_fma_f32 v[58:59], v[210:211], v[210:211], v[58:59]
  v_lshlrev_b32 v48, 16, v8
  v_and_b32 v49, 0xffff0000, v8
  v_pk_fma_f32 v[212:213], v[48:49], v[240:241], v[212:213] op_sel_hi:[1,0,1]
  v_pk_add_f32 v[212:213], v[212:213], v[242:243] op_sel_hi:[1,0]
  v_pk_add_f32 v[56:57], v[56:57], v[212:213]
  v_pk_fma_f32 v[58:59], v[212:213], v[212:213], v[58:59]
  v_lshlrev_b32 v50, 16, v9
  v_and_b32 v51, 0xffff0000, v9
  v_pk_fma_f32 v[214:215], v[50:51], v[240:241], v[214:215] op_sel_hi:[1,0,1]
  v_pk_add_f32 v[214:215], v[214:215], v[242:243] op_sel_hi:[1,0]
  v_pk_add_f32 v[56:57], v[56:57], v[214:215]
  v_pk_fma_f32 v[58:59], v[214:215], v[214:215], v[58:59]
  v_lshlrev_b32 v52, 16, v10
  v_and_b32 v53, 0xffff0000, v10
  v_pk_fma_f32 v[216:217], v[52:53], v[240:241], v[216:217] op_sel_hi:[1,0,1]
  v_pk_add_f32 v[216:217], v[216:217], v[242:243] op_sel_hi:[1,0]
  v_pk_add_f32 v[56:57], v[56:57], v[216:217]
  v_pk_fma_f32 v[58:59], v[216:217], v[216:217], v[58:59]
  v_lshlrev_b32 v54, 16, v11
  v_and_b32 v55, 0xffff0000, v11
  v_pk_fma_f32 v[218:219], v[54:55], v[240:241], v[218:219] op_sel_hi:[1,0,1]
  v_pk_add_f32 v[218:219], v[218:219], v[242:243] op_sel_hi:[1,0]
  v_pk_add_f32 v[56:57], v[56:57], v[218:219]
  v_pk_fma_f32 v[58:59], v[218:219], v[218:219], v[58:59]
  v_lshlrev_b32 v48, 16, v12
  v_and_b32 v49, 0xffff0000, v12
  v_pk_fma_f32 v[220:221], v[48:49], v[240:241], v[220:221] op_sel_hi:[1,0,1]
  v_pk_add_f32 v[220:221], v[220:221], v[242:243] op_sel_hi:[1,0]
  v_pk_add_f32 v[56:57], v[56:57], v[220:221]
  v_pk_fma_f32 v[58:59], v[220:221], v[220:221], v[58:59]
  v_lshlrev_b32 v50, 16, v13
  v_and_b32 v51, 0xffff0000, v13
  v_pk_fma_f32 v[222:223], v[50:51], v[240:241], v[222:223] op_sel_hi:[1,0,1]
  v_pk_add_f32 v[222:223], v[222:223], v[242:243] op_sel_hi:[1,0]
  v_pk_add_f32 v[56:57], v[56:57], v[222:223]
  v_pk_fma_f32 v[58:59], v[222:223], v[222:223], v[58:59]
  v_lshlrev_b32 v52, 16, v14
  v_and_b32 v53, 0xffff0000, v14
  v_pk_fma_f32 v[224:225], v[52:53], v[240:241], v[224:225] op_sel_hi:[1,0,1]
  v_pk_add_f32 v[224:225], v[224:225], v[242:243] op_sel_hi:[1,0]
  v_pk_add_f32 v[56:57], v[56:57], v[224:225]
  v_pk_fma_f32 v[58:59], v[224:225], v[224:225], v[58:59]
  v_lshlrev_b32 v54, 16, v15
  v_and_b32 v55, 0xffff0000, v15
  v_pk_fma_f32 v[226:227], v[54:55], v[240:241], v[226:227] op_sel_hi:[1,0,1]
  v_pk_add_f32 v[226:227], v[226:227], v[242:243] op_sel_hi:[1,0]
  v_pk_add_f32 v[56:57], v[56:57], v[226:227]
  v_pk_fma_f32 v[58:59], v[226:227], v[226:227], v[58:59]
  v_lshlrev_b32 v48, 16, v16
  v_and_b32 v49, 0xffff0000, v16
  v_pk_fma_f32 v[228:229], v[48:49], v[240:241], v[228:229] op_sel_hi:[1,0,1]
  v_pk_add_f32 v[228:229], v[228:229], v[242:243] op_sel_hi:[1,0]
  v_pk_add_f32 v[56:57], v[56:57], v[228:229]
  v_pk_fma_f32 v[58:59], v[228:229], v[228:229], v[58:59]
  v_lshlrev_b32 v50, 16, v17
  v_and_b32 v51, 0xffff0000, v17
  v_pk_fma_f32 v[230:231], v[50:51], v[240:241], v[230:231] op_sel_hi:[1,0,1]
  v_pk_add_f32 v[230:231], v[230:231], v[242:243] op_sel_hi:[1,0]
  v_pk_add_f32 v[56:57], v[56:57], v[230:231]
  v_pk_fma_f32 v[58:59], v[230:231], v[230:231], v[58:59]
  v_lshlrev_b32 v52, 16, v18
  v_and_b32 v53, 0xffff0000, v18
  v_pk_fma_f32 v[232:233], v[52:53], v[240:241], v[232:233] op_sel_hi:[1,0,1]
  v_pk_add_f32 v[232:233], v[232:233], v[242:243] op_sel_hi:[1,0]
  v_pk_add_f32 v[56:57], v[56:57], v[232:233]
  v_pk_fma_f32 v[58:59], v[232:233], v[232:233], v[58:59]
  v_lshlrev_b32 v54, 16, v19
  v_and_b32 v55, 0xffff0000, v19
  v_pk_fma_f32 v[234:235], v[54:55], v[240:241], v[234:235] op_sel_hi:[1,0,1]
  v_pk_add_f32 v[234:235], v[234:235], v[242:243] op_sel_hi:[1,0]
  v_pk_add_f32 v[56:57], v[56:57], v[234:235]
  v_pk_fma_f32 v[58:59], v[234:235], v[234:235], v[58:59]
  v_lshlrev_b32 v48, 16, v20
  v_and_b32 v49, 0xffff0000, v20
  v_pk_fma_f32 v[236:237], v[48:49], v[240:241], v[236:237] op_sel_hi:[1,0,1]
  v_pk_add_f32 v[236:237], v[236:237], v[242:243] op_sel_hi:[1,0]
  v_pk_add_f32 v[56:57], v[56:57], v[236:237]
  v_pk_fma_f32 v[58:59], v[236:237], v[236:237], v[58:59]
  v_lshlrev_b32 v50, 16, v21
  v_and_b32 v51, 0xffff0000, v21
  v_pk_fma_f32 v[238:239], v[50:51], v[240:241], v[238:239] op_sel_hi:[1,0,1]
  v_pk_add_f32 v[238:239], v[238:239], v[242:243] op_sel_hi:[1,0]
  v_pk_add_f32 v[56:57], v[56:57], v[238:239]
  v_pk_fma_f32 v[58:59], v[238:239], v[238:239], v[58:59]
  v_add_f32 v56, v56, v57
  v_add_f32 v57, v58, v59
  v_mov_b32 v58, v56
  v_mov_b32 v59, v57
  s_nop 0
  v_permlane32_swap_b32 v56, v58
  v_permlane32_swap_b32 v57, v59
  v_pk_add_f32 v[56:57], v[56:57], v[58:59]
  v_mov_b32 v58, v56
  v_mov_b32 v59, v57
  s_nop 0
  v_permlane16_swap_b32 v56, v58
  v_permlane16_swap_b32 v57, v59
  v_pk_add_f32 v[56:57], v[56:57], v[58:59]
  s_lshl_b32 s56, s38, 10
  s_lshl_b32 s53, s57, 7
  s_add_u32 s53, s53, s56
  v_or_b32 v57, 1, v57
  s_mov_b64 exec, 0xffff
  buffer_store_dwordx2 v[56:57], v245, s[20:23], s53 offen sc1
  s_mov_b64 exec, -1
  s_mul_i32 s53, s38, 18432
  s_lshl_b32 s54, s58, 9
  s_add_u32 s53, s53, s54
  v_lshlrev_b32 v244, 3, v1
  s_mov_b32 s60, 0
  v_cvt_pk_bf16_f32 v60, v204, v205
  v_cvt_pk_bf16_f32 v61, v206, v207
  buffer_store_dwordx2 v[60:61], v244, s[24:27], s53 offen offset:0 sc1
  v_cvt_pk_bf16_f32 v62, v208, v209
  v_cvt_pk_bf16_f32 v63, v210, v211
  buffer_store_dwordx2 v[62:63], v244, s[24:27], s53 offen offset:512 sc1
  v_cvt_pk_bf16_f32 v64, v212, v213
  v_cvt_pk_bf16_f32 v65, v214, v215
  buffer_store_dwordx2 v[64:65], v244, s[24:27], s53 offen offset:1024 sc1
  v_cvt_pk_bf16_f32 v66, v216, v217
  v_cvt_pk_bf16_f32 v67, v218, v219
  buffer_store_dwordx2 v[66:67], v244, s[24:27], s53 offen offset:1536 sc1
  v_cvt_pk_bf16_f32 v68, v220, v221
  v_cvt_pk_bf16_f32 v69, v222, v223
  buffer_store_dwordx2 v[68:69], v244, s[24:27], s53 offen offset:2048 sc1
  v_cvt_pk_bf16_f32 v70, v224, v225
  v_cvt_pk_bf16_f32 v71, v226, v227
  buffer_store_dwordx2 v[70:71], v244, s[24:27], s53 offen offset:2560 sc1
  v_cvt_pk_bf16_f32 v72, v228, v229
  v_cvt_pk_bf16_f32 v73, v230, v231
  buffer_store_dwordx2 v[72:73], v244, s[24:27], s53 offen offset:3072 sc1
  v_cvt_pk_bf16_f32 v74, v232, v233
  v_cvt_pk_bf16_f32 v75, v234, v235
  buffer_store_dwordx2 v[74:75], v244, s[24:27], s53 offen offset:3584 sc1
  v_cvt_pk_bf16_f32 v76, v236, v237
  v_cvt_pk_bf16_f32 v77, v238, v239
  s_add_u32 s53, s53, 4096
  buffer_store_dwordx2 v[76:77], v244, s[24:27], s53 offen offset:0 sc1
K2_SPIN:
  buffer_load_dwordx2 v[28:29], v244, s[20:23], s56 offen sc1
  s_add_u32 s60, s60, 1
  s_waitcnt vmcnt(0)
  v_cmp_eq_u32 vcc, 0, v29
  s_nop 0
  s_cbranch_vccz K2_SPUN
  s_sleep 8
  s_cmp_lt_u32 s60, 0x20000
  s_cbranch_scc1 K2_SPIN
K2_SPUN:
  s_mov_b32 s53, 987991609
  s_mov_b32 s54, 925353388
  v_mov_b32 v30, v28
  v_mov_b32 v31, v29
  s_nop 0
  v_permlane32_swap_b32 v28, v30
  v_permlane32_swap_b32 v29, v31
  v_pk_add_f32 v[28:29], v[28:29], v[30:31]
  v_mov_b32 v30, v28
  v_mov_b32 v31, v29
  s_nop 0
  v_permlane16_swap_b32 v28, v30
  v_permlane16_swap_b32 v29, v31
  v_pk_add_f32 v[28:29], v[28:29], v[30:31]
  v_mul_f32 v28, s53, v28
  v_mul_f32 v29, s53, v29
  v_fma_f32 v29, -v28, v28, v29
  v_max_f32 v29, 0, v29
  v_add_f32 v29, s54, v29
  v_rsq_f32 v30, v29
  s_nop 0
  v_mul_f32 v32, -v28, v30
  s_lshr_b32 s53, s38, 1
  s_mul_i32 s53, s53, 36864
  s_lshl_b32 s54, s58, 10
  s_add_u32 s53, s53, s54
  s_and_b32 s54, s38, 1
  s_lshl_b32 s54, s54, 8
  s_add_u32 s53, s53, s54
  v_lshrrev_b32 v244, 1, v3
  v_lshlrev_b32 v244, 9, v244
  v_lshl_add_u32 v244, v2, 4, v244
  v_and_b32 v245, 1, v3
  v_lshl_add_u32 v244, v245, 3, v244
  v_pk_fma_f32 v[204:205], v[204:205], v[30:31], v[32:33] op_sel_hi:[1,0,0]
  v_pk_fma_f32 v[206:207], v[206:207], v[30:31], v[32:33] op_sel_hi:[1,0,0]
  v_cvt_pk_bf16_f32 v80, v204, v205
  v_cvt_pk_bf16_f32 v81, v206, v207
  buffer_store_dwordx2 v[80:81], v244, s[28:31], s53 offen offset:0 sc1
  v_pk_fma_f32 v[208:209], v[208:209], v[30:31], v[32:33] op_sel_hi:[1,0,0]
  v_pk_fma_f32 v[210:211], v[210:211], v[30:31], v[32:33] op_sel_hi:[1,0,0]
  v_cvt_pk_bf16_f32 v82, v208, v209
  v_cvt_pk_bf16_f32 v83, v210, v211
  buffer_store_dwordx2 v[82:83], v244, s[28:31], s53 offen offset:1024 sc1
  v_pk_fma_f32 v[212:213], v[212:213], v[30:31], v[32:33] op_sel_hi:[1,0,0]
  v_pk_fma_f32 v[214:215], v[214:215], v[30:31], v[32:33] op_sel_hi:[1,0,0]
  v_cvt_pk_bf16_f32 v84, v212, v213
  v_cvt_pk_bf16_f32 v85, v214, v215
  buffer_store_dwordx2 v[84:85], v244, s[28:31], s53 offen offset:2048 sc1
  v_pk_fma_f32 v[216:217], v[216:217], v[30:31], v[32:33] op_sel_hi:[1,0,0]
  v_pk_fma_f32 v[218:219], v[218:219], v[30:31], v[32:33] op_sel_hi:[1,0,0]
  v_cvt_pk_bf16_f32 v86, v216, v217
  v_cvt_pk_bf16_f32 v87, v218, v219
  buffer_store_dwordx2 v[86:87], v244, s[28:31], s53 offen offset:3072 sc1
  v_pk_fma_f32 v[220:221], v[220:221], v[30:31], v[32:33] op_sel_hi:[1,0,0]
  v_pk_fma_f32 v[222:223], v[222:223], v[30:31], v[32:33] op_sel_hi:[1,0,0]
  v_cvt_pk_bf16_f32 v88, v220, v221
  v_cvt_pk_bf16_f32 v89, v222, v223
  s_add_u32 s53, s53, 4096
  buffer_store_dwordx2 v[88:89], v244, s[28:31], s53 offen offset:0 sc1
  v_pk_fma_f32 v[224:225], v[224:225], v[30:31], v[32:33] op_sel_hi:[1,0,0]
  v_pk_fma_f32 v[226:227], v[226:227], v[30:31], v[32:33] op_sel_hi:[1,0,0]
  v_cvt_pk_bf16_f32 v90, v224, v225
  v_cvt_pk_bf16_f32 v91, v226, v227
  buffer_store_dwordx2 v[90:91], v244, s[28:31], s53 offen offset:1024 sc1
  v_pk_fma_f32 v[228:229], v[228:229], v[30:31], v[32:33] op_sel_hi:[1,0,0]
  v_pk_fma_f32 v[230:231], v[230:231], v[30:31], v[32:33] op_sel_hi:[1,0,0]
  v_cvt_pk_bf16_f32 v92, v228, v229
  v_cvt_pk_bf16_f32 v93, v230, v231
  buffer_store_dwordx2 v[92:93], v244, s[28:31], s53 offen offset:2048 sc1
  v_pk_fma_f32 v[232:233], v[232:233], v[30:31], v[32:33] op_sel_hi:[1,0,0]
  v_pk_fma_f32 v[234:235], v[234:235], v[30:31], v[32:33] op_sel_hi:[1,0,0]
  v_cvt_pk_bf16_f32 v94, v232, v233
  v_cvt_pk_bf16_f32 v95, v234, v235
  buffer_store_dwordx2 v[94:95], v244, s[28:31], s53 offen offset:3072 sc1
  v_pk_fma_f32 v[236:237], v[236:237], v[30:31], v[32:33] op_sel_hi:[1,0,0]
  v_pk_fma_f32 v[238:239], v[238:239], v[30:31], v[32:33] op_sel_hi:[1,0,0]
  v_cvt_pk_bf16_f32 v96, v236, v237
  v_cvt_pk_bf16_f32 v97, v238, v239
  s_add_u32 s53, s53, 4096
  buffer_store_dwordx2 v[96:97], v244, s[28:31], s53 offen offset:0 sc1
  s_lshr_b32 s52, s38, 3
  s_lshl_b32 s52, s52, 7
  s_add_u32 s52, s52, 2048
  s_add_u32 s20, s4, 2490368
  s_addc_u32 s21, s5, 0
  s_mov_b32 s22, 147456
  s_mov_b32 s23, 0x20000
  v_mov_b32 v2, 0
  v_mov_b32 v3, 1
  s_mov_b64 exec, 1
  s_waitcnt vmcnt(0)
  buffer_atomic_add v3, v2, s[20:23], s52 offen sc1
  s_mov_b64 exec, -1
  v_mov_b32 v2, 153604
  s_mov_b64 exec, 1
  ds_add_u32 v2, v3
  s_mov_b64 exec, -1
  s_branch K3_ENTRY
K2_REPACK:
  s_waitcnt vmcnt(0)
  s_barrier
  s_cmp_ge_u32 s39, 432
  s_cbranch_scc1 K3_ENTRY
  s_mul_i32 s75, s39, 1821
  s_lshr_b32 s75, s75, 16
  s_mul_i32 s60, s75, 36
  s_sub_u32 s60, s39, s60
  s_mul_i32 s70, s60, 147456
  s_mul_i32 s71, s75, 768
  s_add_u32 s70, s70, s71
  s_add_u32 s71, s70, 73728
  s_mul_i32 s73, s75, 442368
  s_lshl_b32 s60, s60, 10
  s_add_u32 s73, s73, s60
  s_lshl_b32 s62, s75, 7
  s_add_u32 s62, s62, 8192
  v_lshrrev_b32 v112, 3, v1
  v_mul_u32_u24 v112, 9216, v112
  v_and_b32 v113, 7, v1
  v_lshl_add_u32 v112, v113, 4, v112
  s_mov_b32 s24, s44
  s_mov_b32 s25, s45
  s_mov_b32 s26, 5308416
  s_mov_b32 s27, 0x20000
  buffer_load_dwordx4 v[128:131], v112, s[24:27], s70 offen offset:0
  buffer_load_dwordx4 v[132:135], v112, s[24:27], s71 offen offset:0
  buffer_load_dwordx4 v[136:139], v112, s[24:27], s70 offen offset:128
  buffer_load_dwordx4 v[140:143], v112, s[24:27], s71 offen offset:128
  buffer_load_dwordx4 v[144:147], v112, s[24:27], s70 offen offset:256
  buffer_load_dwordx4 v[148:151], v112, s[24:27], s71 offen offset:256
  buffer_load_dwordx4 v[152:155], v112, s[24:27], s70 offen offset:384
  buffer_load_dwordx4 v[156:159], v112, s[24:27], s71 offen offset:384
  buffer_load_dwordx4 v[160:163], v112, s[24:27], s70 offen offset:512
  buffer_load_dwordx4 v[164:167], v112, s[24:27], s71 offen offset:512
  buffer_load_dwordx4 v[168:171], v112, s[24:27], s70 offen offset:640
  buffer_load_dwordx4 v[172:175], v112, s[24:27], s71 offen offset:640
  v_add_u32 v112, 0, v1
  v_mul_u32_u24 v113, 5462, v112
  v_lshrrev_b32 v113, 16, v113
  v_mul_u32_u24 v114, 12, v113
  v_sub_u32 v112, v112, v114
  v_lshrrev_b32 v100, 3, v113
  v_bfe_u32 v101, v113, 2, 1
  v_bfe_u32 v102, v113, 1, 1
  v_and_b32 v113, 1, v113
  v_mul_u32_u24 v113, 1152, v113
  v_lshl_add_u32 v103, v112, 4, v113
  v_add_u32 v112, 64, v1
  v_mul_u32_u24 v113, 5462, v112
  v_lshrrev_b32 v113, 16, v113
  v_mul_u32_u24 v114, 12, v113
  v_sub_u32 v112, v112, v114
  v_lshrrev_b32 v104, 3, v113
  v_bfe_u32 v105, v113, 2, 1
  v_bfe_u32 v106, v113, 1, 1
  v_and_b32 v113, 1, v113
  v_mul_u32_u24 v113, 1152, v113
  v_lshl_add_u32 v107, v112, 4, v113
  v_add_u32 v112, 128, v1
  v_mul_u32_u24 v113, 5462, v112
  v_lshrrev_b32 v113, 16, v113
  v_mul_u32_u24 v114, 12, v113
  v_sub_u32 v112, v112, v114
  v_lshrrev_b32 v108, 3, v113
  v_bfe_u32 v109, v113, 2, 1
  v_bfe_u32 v110, v113, 1, 1
  v_and_b32 v113, 1, v113
  v_mul_u32_u24 v113, 1152, v113
  v_lshl_add_u32 v111, v112, 4, v113
  s_mul_i32 s75, s39, 1214
  s_lshr_b32 s75, s75, 16
  s_mul_i32 s61, s75, 54
  s_sub_u32 s61, s39, s61
  s_mul_i32 s61, s61, 3
  s_mul_i32 s60, s75, 144
  s_and_b32 s49, s60, 63
  s_andn2_b32 s60, s60, 63
  s_mul_i32 s74, s75, 162
  s_add_u32 s74, s74, s61
  s_mul_i32 s74, s74, 4608
  s_lshl_b32 s75, s75, 7
  s_add_u32 s75, s75, 10240
  s_mov_b32 s27, 0x20000
  s_add_u32 s63, s61, 0
  s_sub_u32 s70, s63, 18
  s_lshl_b32 s70, s70, 5
  s_mul_i32 s71, s63, 36
  s_mov_b32 s26, 5308416
  s_movk_i32 s64, 18432
  s_cmp_lt_u32 s63, 18
  s_cselect_b32 s24, s40, s46
  s_cselect_b32 s25, s41, s47
  s_cselect_b32 s26, 663552, s26
  s_cselect_b32 s64, 20736, s64
  s_cselect_b32 s70, s71, s70
  s_movk_i32 s65, 4608
  s_movk_i32 s66, 2304
  s_movk_i32 s67, 9216
  s_sub_u32 s72, s63, 16
  s_mul_i32 s71, s72, 288
  s_add_u32 s71, s71, 16
  s_cmp_lt_u32 s72, 2
  s_cselect_b32 s64, 165888, s64
  s_cselect_b32 s65, 82944, s65
  s_cselect_b32 s66, 20736, s66
  s_cselect_b32 s67, 41472, s67
  s_cselect_b32 s70, s71, s70
  s_mul_i32 s70, s70, 1152
  s_add_u32 s70, s70, s60
  s_add_u32 s71, s70, s67
  v_mad_u32_u24 v112, v100, s64, v103
  v_mad_u32_u24 v112, v101, s65, v112
  v_mad_u32_u24 v112, v102, s66, v112
  v_mad_u32_u24 v113, v104, s64, v107
  v_mad_u32_u24 v113, v105, s65, v113
  v_mad_u32_u24 v113, v106, s66, v113
  v_mad_u32_u24 v114, v108, s64, v111
  v_mad_u32_u24 v114, v109, s65, v114
  v_mad_u32_u24 v114, v110, s66, v114
  buffer_load_dwordx4 v[176:179], v112, s[24:27], s70 offen
  buffer_load_dwordx4 v[180:183], v113, s[24:27], s70 offen
  buffer_load_dwordx4 v[184:187], v114, s[24:27], s70 offen
  buffer_load_dwordx4 v[188:191], v112, s[24:27], s71 offen
  buffer_load_dwordx4 v[192:195], v113, s[24:27], s71 offen
  buffer_load_dwordx4 v[196:199], v114, s[24:27], s71 offen
  s_add_u32 s63, s61, 1
  s_sub_u32 s70, s63, 18
  s_lshl_b32 s70, s70, 5
  s_mul_i32 s71, s63, 36
  s_mov_b32 s26, 5308416
  s_movk_i32 s64, 18432
  s_cmp_lt_u32 s63, 18
  s_cselect_b32 s24, s40, s46
  s_cselect_b32 s25, s41, s47
  s_cselect_b32 s26, 663552, s26
  s_cselect_b32 s64, 20736, s64
  s_cselect_b32 s70, s71, s70
  s_movk_i32 s65, 4608
  s_movk_i32 s66, 2304
  s_movk_i32 s67, 9216
  s_sub_u32 s72, s63, 16
  s_mul_i32 s71, s72, 288
  s_add_u32 s71, s71, 16
  s_cmp_lt_u32 s72, 2
  s_cselect_b32 s64, 165888, s64
  s_cselect_b32 s65, 82944, s65
  s_cselect_b32 s66, 20736, s66
  s_cselect_b32 s67, 41472, s67
  s_cselect_b32 s70, s71, s70
  s_mul_i32 s70, s70, 1152
  s_add_u32 s70, s70, s60
  s_add_u32 s71, s70, s67
  v_mad_u32_u24 v112, v100, s64, v103
  v_mad_u32_u24 v112, v101, s65, v112
  v_mad_u32_u24 v112, v102, s66, v112
  v_mad_u32_u24 v113, v104, s64, v107
  v_mad_u32_u24 v113, v105, s65, v113
  v_mad_u32_u24 v113, v106, s66, v113
  v_mad_u32_u24 v114, v108, s64, v111
  v_mad_u32_u24 v114, v109, s65, v114
  v_mad_u32_u24 v114, v110, s66, v114
  buffer_load_dwordx4 v[200:203], v112, s[24:27], s70 offen
  buffer_load_dwordx4 v[204:207], v113, s[24:27], s70 offen
  buffer_load_dwordx4 v[208:211], v114, s[24:27], s70 offen
  buffer_load_dwordx4 v[212:215], v112, s[24:27], s71 offen
  buffer_load_dwordx4 v[216:219], v113, s[24:27], s71 offen
  buffer_load_dwordx4 v[220:223], v114, s[24:27], s71 offen
  s_add_u32 s63, s61, 2
  s_sub_u32 s70, s63, 18
  s_lshl_b32 s70, s70, 5
  s_mul_i32 s71, s63, 36
  s_mov_b32 s26, 5308416
  s_movk_i32 s64, 18432
  s_cmp_lt_u32 s63, 18
  s_cselect_b32 s24, s40, s46
  s_cselect_b32 s25, s41, s47
  s_cselect_b32 s26, 663552, s26
  s_cselect_b32 s64, 20736, s64
  s_cselect_b32 s70, s71, s70
  s_movk_i32 s65, 4608
  s_movk_i32 s66, 2304
  s_movk_i32 s67, 9216
  s_sub_u32 s72, s63, 16
  s_mul_i32 s71, s72, 288
  s_add_u32 s71, s71, 16
  s_cmp_lt_u32 s72, 2
  s_cselect_b32 s64, 165888, s64
  s_cselect_b32 s65, 82944, s65
  s_cselect_b32 s66, 20736, s66
  s_cselect_b32 s67, 41472, s67
  s_cselect_b32 s70, s71, s70
  s_mul_i32 s70, s70, 1152
  s_add_u32 s70, s70, s60
  s_add_u32 s71, s70, s67
  v_mad_u32_u24 v112, v100, s64, v103
  v_mad_u32_u24 v112, v101, s65, v112
  v_mad_u32_u24 v112, v102, s66, v112
  v_mad_u32_u24 v113, v104, s64, v107
  v_mad_u32_u24 v113, v105, s65, v113
  v_mad_u32_u24 v113, v106, s66, v113
  v_mad_u32_u24 v114, v108, s64, v111
  v_mad_u32_u24 v114, v109, s65, v114
  v_mad_u32_u24 v114, v110, s66, v114
  buffer_load_dwordx4 v[224:227], v112, s[24:27], s70 offen
  buffer_load_dwordx4 v[228:231], v113, s[24:27], s70 offen
  buffer_load_dwordx4 v[232:235], v114, s[24:27], s70 offen
  buffer_load_dwordx4 v[236:239], v112, s[24:27], s71 offen
  buffer_load_dwordx4 v[240:243], v113, s[24:27], s71 offen
  buffer_load_dwordx4 v[244:247], v114, s[24:27], s71 offen
  s_mul_i32 s63, s37, 3072
  s_add_u32 s63, s63, 151552
  v_lshlrev_b32 v4, 4, v1
  v_add_u32 v5, s63, v4
  v_and_b32 v8, 3, v1
  v_lshrrev_b32 v6, 5, v1
  v_lshlrev_b32 v6, 3, v6
  v_bfe_u32 v7, v1, 2, 2
  v_add_u32 v6, v6, v7
  v_lshlrev_b32 v6, 7, v6
  v_bfe_u32 v7, v1, 4, 1
  v_lshl_add_u32 v6, v7, 5, v6
  v_lshl_add_u32 v6, v8, 3, v6
  v_add_u32 v6, s63, v6
  s_add_u32 s16, s4, 18874368
  s_addc_u32 s17, s5, 0
  s_mov_b32 s18, 5308416
  s_mov_b32 s19, 0x20000
  s_waitcnt vmcnt(18)
  ds_write_b128 v5, v[128:131] offset:0
  ds_write_b128 v5, v[132:135] offset:1024
  ds_read_b64_tr_b16 v[12:13], v6 offset:0
  ds_read_b64_tr_b16 v[14:15], v6 offset:512
  ds_read_b64_tr_b16 v[16:17], v6 offset:64
  ds_read_b64_tr_b16 v[18:19], v6 offset:576
  ds_write_b128 v5, v[136:139] offset:0
  ds_write_b128 v5, v[140:143] offset:1024
  ds_read_b64_tr_b16 v[20:21], v6 offset:0
  ds_read_b64_tr_b16 v[22:23], v6 offset:512
  ds_read_b64_tr_b16 v[24:25], v6 offset:64
  ds_read_b64_tr_b16 v[26:27], v6 offset:576
  ds_write_b128 v5, v[144:147] offset:0
  ds_write_b128 v5, v[148:151] offset:1024
  ds_read_b64_tr_b16 v[28:29], v6 offset:0
  ds_read_b64_tr_b16 v[30:31], v6 offset:512
  ds_read_b64_tr_b16 v[32:33], v6 offset:64
  ds_read_b64_tr_b16 v[34:35], v6 offset:576
  ds_write_b128 v5, v[152:155] offset:0
  ds_write_b128 v5, v[156:159] offset:1024
  ds_read_b64_tr_b16 v[36:37], v6 offset:0
  ds_read_b64_tr_b16 v[38:39], v6 offset:512
  ds_read_b64_tr_b16 v[40:41], v6 offset:64
  ds_read_b64_tr_b16 v[42:43], v6 offset:576
  ds_write_b128 v5, v[160:163] offset:0
  ds_write_b128 v5, v[164:167] offset:1024
  ds_read_b64_tr_b16 v[44:45], v6 offset:0
  ds_read_b64_tr_b16 v[46:47], v6 offset:512
  ds_read_b64_tr_b16 v[48:49], v6 offset:64
  ds_read_b64_tr_b16 v[50:51], v6 offset:576
  ds_write_b128 v5, v[168:171] offset:0
  ds_write_b128 v5, v[172:175] offset:1024
  ds_read_b64_tr_b16 v[52:53], v6 offset:0
  ds_read_b64_tr_b16 v[54:55], v6 offset:512
  ds_read_b64_tr_b16 v[56:57], v6 offset:64
  ds_read_b64_tr_b16 v[58:59], v6 offset:576
  s_waitcnt lgkmcnt(15)
  buffer_store_dwordx4 v[12:15], v4, s[16:19], s73 offen sc1
  s_add_u32 s73, s73, 36864
  buffer_store_dwordx4 v[16:19], v4, s[16:19], s73 offen sc1
  s_add_u32 s73, s73, 36864
  s_waitcnt lgkmcnt(15)
  buffer_store_dwordx4 v[20:23], v4, s[16:19], s73 offen sc1
  s_add_u32 s73, s73, 36864
  buffer_store_dwordx4 v[24:27], v4, s[16:19], s73 offen sc1
  s_add_u32 s73, s73, 36864
  s_waitcnt lgkmcnt(15)
  buffer_store_dwordx4 v[28:31], v4, s[16:19], s73 offen sc1
  s_add_u32 s73, s73, 36864
  buffer_store_dwordx4 v[32:35], v4, s[16:19], s73 offen sc1
  s_add_u32 s73, s73, 36864
  s_waitcnt lgkmcnt(12)
  buffer_store_dwordx4 v[36:39], v4, s[16:19], s73 offen sc1
  s_add_u32 s73, s73, 36864
  buffer_store_dwordx4 v[40:43], v4, s[16:19], s73 offen sc1
  s_add_u32 s73, s73, 36864
  s_waitcnt lgkmcnt(6)
  buffer_store_dwordx4 v[44:47], v4, s[16:19], s73 offen sc1
  s_add_u32 s73, s73, 36864
  buffer_store_dwordx4 v[48:51], v4, s[16:19], s73 offen sc1
  s_add_u32 s73, s73, 36864
  s_waitcnt lgkmcnt(0)
  buffer_store_dwordx4 v[52:55], v4, s[16:19], s73 offen sc1
  s_add_u32 s73, s73, 36864
  buffer_store_dwordx4 v[56:59], v4, s[16:19], s73 offen sc1
  s_add_u32 s73, s73, 36864
  s_add_u32 s16, s4, 25165824
  s_addc_u32 s17, s5, 0
  s_mov_b32 s18, 5971968
  s_mov_b32 s19, 0x20000
  v_lshrrev_b32 v6, 2, v1
  v_mul_u32_u24 v6, 192, v6
  s_add_u32 s49, s49, s63
  v_add_u32 v6, s49, v6
  v_and_b32 v7, 1, v1
  v_lshl_add_u32 v7, v7, 3, v6
  v_lshl_add_u32 v6, v8, 3, v6
  v_lshrrev_b32 v8, 4, v1
  v_lshlrev_b32 v8, 7, v8
  v_and_b32 v9, 15, v1
  v_lshl_add_u32 v8, v9, 4, v8
  v_cmp_gt_u32 vcc, 8, v9
  v_mov_b32 v9, 1073741824
  s_nop 0
  v_cndmask_b32 v8, v9, v8, vcc
  s_waitcnt vmcnt(27)
  ds_write_b128 v5, v[176:179] offset:0
  ds_write_b128 v5, v[180:183] offset:1024
  ds_write_b128 v5, v[184:187] offset:2048
  ds_read_b64_tr_b16 v[60:61], v6 offset:0
  ds_read_b64_tr_b16 v[64:65], v6 offset:32
  ds_read_b64_tr_b16 v[68:69], v6 offset:64
  ds_read_b64_tr_b16 v[72:73], v6 offset:96
  ds_read_b64_tr_b16 v[76:77], v7 offset:128
  s_waitcnt vmcnt(24)
  ds_write_b128 v5, v[188:191] offset:0
  ds_write_b128 v5, v[192:195] offset:1024
  ds_write_b128 v5, v[196:199] offset:2048
  ds_read_b64_tr_b16 v[62:63], v6 offset:0
  ds_read_b64_tr_b16 v[66:67], v6 offset:32
  ds_read_b64_tr_b16 v[70:71], v6 offset:64
  ds_read_b64_tr_b16 v[74:75], v6 offset:96
  ds_read_b64_tr_b16 v[78:79], v7 offset:128
  s_waitcnt vmcnt(21)
  ds_write_b128 v5, v[200:203] offset:0
  ds_write_b128 v5, v[204:207] offset:1024
  ds_write_b128 v5, v[208:211] offset:2048
  ds_read_b64_tr_b16 v[80:81], v6 offset:0
  ds_read_b64_tr_b16 v[84:85], v6 offset:32
  ds_read_b64_tr_b16 v[88:89], v6 offset:64
  ds_read_b64_tr_b16 v[92:93], v6 offset:96
  ds_read_b64_tr_b16 v[96:97], v7 offset:128
  s_waitcnt vmcnt(18)
  ds_write_b128 v5, v[212:215] offset:0
  ds_write_b128 v5, v[216:219] offset:1024
  ds_write_b128 v5, v[220:223] offset:2048
  ds_read_b64_tr_b16 v[82:83], v6 offset:0
  ds_read_b64_tr_b16 v[86:87], v6 offset:32
  ds_read_b64_tr_b16 v[90:91], v6 offset:64
  ds_read_b64_tr_b16 v[94:95], v6 offset:96
  ds_read_b64_tr_b16 v[98:99], v7 offset:128
  s_waitcnt vmcnt(15)
  ds_write_b128 v5, v[224:227] offset:0
  ds_write_b128 v5, v[228:231] offset:1024
  ds_write_b128 v5, v[232:235] offset:2048
  ds_read_b64_tr_b16 v[100:101], v6 offset:0
  ds_read_b64_tr_b16 v[104:105], v6 offset:32
  ds_read_b64_tr_b16 v[108:109], v6 offset:64
  ds_read_b64_tr_b16 v[112:113], v6 offset:96
  ds_read_b64_tr_b16 v[116:117], v7 offset:128
  s_waitcnt vmcnt(12)
  ds_write_b128 v5, v[236:239] offset:0
  ds_write_b128 v5, v[240:243] offset:1024
  ds_write_b128 v5, v[244:247] offset:2048
  ds_read_b64_tr_b16 v[102:103], v6 offset:0
  ds_read_b64_tr_b16 v[106:107], v6 offset:32
  ds_read_b64_tr_b16 v[110:111], v6 offset:64
  ds_read_b64_tr_b16 v[114:115], v6 offset:96
  ds_read_b64_tr_b16 v[118:119], v7 offset:128
  s_waitcnt lgkmcnt(15)
  buffer_store_dwordx4 v[60:63], v4, s[16:19], s74 offen offset:0 sc1
  buffer_store_dwordx4 v[64:67], v4, s[16:19], s74 offen offset:1024 sc1
  buffer_store_dwordx4 v[68:71], v4, s[16:19], s74 offen offset:2048 sc1
  buffer_store_dwordx4 v[72:75], v4, s[16:19], s74 offen offset:3072 sc1
  s_add_u32 s74, s74, 4096
  buffer_store_dwordx4 v[76:79], v8, s[16:19], s74 offen sc1
  s_add_u32 s74, s74, 512
  s_waitcnt lgkmcnt(15)
  buffer_store_dwordx4 v[80:83], v4, s[16:19], s74 offen offset:0 sc1
  buffer_store_dwordx4 v[84:87], v4, s[16:19], s74 offen offset:1024 sc1
  buffer_store_dwordx4 v[88:91], v4, s[16:19], s74 offen offset:2048 sc1
  buffer_store_dwordx4 v[92:95], v4, s[16:19], s74 offen offset:3072 sc1
  s_add_u32 s74, s74, 4096
  buffer_store_dwordx4 v[96:99], v8, s[16:19], s74 offen sc1
  s_add_u32 s74, s74, 512
  s_waitcnt lgkmcnt(0)
  buffer_store_dwordx4 v[100:103], v4, s[16:19], s74 offen offset:0 sc1
  buffer_store_dwordx4 v[104:107], v4, s[16:19], s74 offen offset:1024 sc1
  buffer_store_dwordx4 v[108:111], v4, s[16:19], s74 offen offset:2048 sc1
  buffer_store_dwordx4 v[112:115], v4, s[16:19], s74 offen offset:3072 sc1
  s_add_u32 s74, s74, 4096
  buffer_store_dwordx4 v[116:119], v8, s[16:19], s74 offen sc1
  s_add_u32 s74, s74, 512
  s_add_u32 s20, s4, 2490368
  s_addc_u32 s21, s5, 0
  s_mov_b32 s22, 147456
  s_mov_b32 s23, 0x20000
  v_mov_b32 v2, 0
  v_mov_b32 v3, 1
  s_mov_b64 exec, 1
  s_waitcnt vmcnt(0)
  buffer_atomic_add v3, v2, s[20:23], s62 offen sc1
  s_mov_b64 exec, -1
  s_branch K3_ENTRY
K2_END:
  s_mov_b32 s48, s36
K2_END2:
K2_EXIT:
  s_endpgm
K3_ENTRY:
  s_load_dwordx4 s[44:47], s[0:1], 64
  s_mov_b32 s48, s36
  s_and_b32 s36, s36, 3
  s_mov_b32 s49, s39
  s_setprio 3
  v_mov_b32 v9, 0
  s_and_b32 s52, s50, 1
  s_lshl_b32 s52, s52, 3
  s_and_b32 s53, s51, 7
  s_add_u32 s37, s52, s53
  s_lshr_b32 s52, s50, 1
  s_lshl_b32 s52, s52, 2
  s_lshr_b32 s53, s51, 3
  s_add_u32 s38, s52, s53
  v_lshlrev_b32 v3, 4, v1
  v_mov_b32 v2, v3
  s_mul_i32 s40, s36, 9216
  s_mov_b32 s58, s40
  s_mov_b32 s39, 0
  s_mul_i32 s52, s38, 331776
  s_lshl_b32 s53, s37, 2
  s_add_u32 s53, s53, s36
  s_mul_i32 s55, s53, 36864
  s_waitcnt lgkmcnt(0)
  s_add_u32 s12, s4, s52
  s_addc_u32 s13, s5, 0
  s_add_u32 s12, s12, 18874368
  s_addc_u32 s13, s13, 0
  s_mov_b32 s14, 331776
  s_mov_b32 s15, 0x20000
  s_add_u32 s8, s4, 15728640
  s_addc_u32 s9, s5, 0
  s_mov_b32 s10, 2359296
  s_mov_b32 s11, 0x20000
  s_add_u32 s24, s4, 2490368
  s_addc_u32 s25, s5, 0
  s_mov_b32 s26, 147456
  s_mov_b32 s27, 0x20000
  s_lshl_b32 s56, s37, 7
  s_add_u32 s56, s56, 2048
  s_mov_b32 s59, 0
  s_mul_i32 s57, s38, 9
  v_lshl_add_u32 v11, v1, 3, s57
  v_mul_u32_u24 v11, 5462, v11
  v_lshrrev_b32 v11, 16, v11
  v_lshlrev_b32 v11, 7, v11
  s_movk_i32 s57, 8192
  s_lshr_b32 s70, s50, 2
  s_lshl_b32 s70, s70, 2
  s_lshr_b32 s71, s51, 3
  s_add_u32 s70, s70, s71
  s_lshl_b32 s70, s70, 7
  s_add_u32 s70, s70, 10240
  s_cmp_ge_u32 s49, 432
  s_cbranch_scc1 K3_NOSG
  v_mov_b32 v10, 1
  s_mov_b64 exec, 1
  buffer_atomic_add v10, v9, s[24:27], s75 offen sc1
  s_mov_b64 exec, -1
K3_NOSG:
  v_mov_b32 v8, 153604
K3_LS0:
  ds_read_b32 v10, v8
  s_waitcnt lgkmcnt(0)
  v_readfirstlane_b32 s61, v10
  s_nop 0
  s_cmp_ge_u32 s61, 2
  s_cbranch_scc1 K3_LG0
  s_sleep 8
  s_branch K3_LS0
K3_LG0:
  s_mov_b64 exec, 3
K3_POLL1:
  buffer_load_dword v10, v11, s[24:27], s57 offen sc1
  s_add_u32 s59, s59, 1
  s_waitcnt vmcnt(0)
  v_cmp_gt_u32 vcc, 36, v10
  s_cmp_ge_u32 s59, 0x8000
  s_cbranch_scc1 K3_GO1
  s_cbranch_vccz K3_GO1
  s_sleep 32
  s_branch K3_POLL1
K3_GO1:
  s_mov_b64 exec, -1
  v_mov_b32 v8, 153600
  s_mov_b64 exec, 1
K3_W:
  buffer_load_dword v10, v9, s[24:27], s56 offen sc1
  ds_read_b32 v12, v8
  s_waitcnt vmcnt(0) lgkmcnt(0)
  v_readfirstlane_b32 s61, v10
  v_readfirstlane_b32 s62, v12
  s_cmp_ge_u32 s61, 32
  s_cbranch_scc1 K3_XF
  s_cmp_ge_u32 s62, 4
  s_cbranch_scc1 K3_RF
  s_sleep 8
  s_branch K3_W
K3_RF:
  s_mov_b64 exec, -1
  s_add_u32 s60, s58, s39
  s_add_u32 m0, s60, 0
  s_add_u32 s62, s40, 0
  buffer_load_dwordx4 v3, s[12:15], s62 offen offset:0 sc1 lds
  buffer_load_dwordx4 v3, s[12:15], s62 offen offset:1024 sc1 lds
  buffer_load_dwordx4 v3, s[12:15], s62 offen offset:2048 sc1 lds
  buffer_load_dwordx4 v3, s[12:15], s62 offen offset:3072 sc1 lds
  s_add_u32 m0, s60, 4096
  s_add_u32 s62, s40, 4096
  buffer_load_dwordx4 v3, s[12:15], s62 offen offset:0 sc1 lds
  buffer_load_dwordx4 v3, s[12:15], s62 offen offset:1024 sc1 lds
  buffer_load_dwordx4 v3, s[12:15], s62 offen offset:2048 sc1 lds
  buffer_load_dwordx4 v3, s[12:15], s62 offen offset:3072 sc1 lds
  s_add_u32 m0, s60, 8192
  s_add_u32 s62, s40, 8192
  buffer_load_dwordx4 v3, s[12:15], s62 offen offset:0 sc1 lds
  s_add_u32 s40, s40, 36864
  s_add_u32 s39, s39, 36864
  s_cmp_eq_u32 s39, 147456
  s_cselect_b32 s39, 0, s39
  s_add_u32 s60, s58, s39
  s_add_u32 m0, s60, 0
  s_add_u32 s62, s40, 0
  buffer_load_dwordx4 v3, s[12:15], s62 offen offset:0 sc1 lds
  buffer_load_dwordx4 v3, s[12:15], s62 offen offset:1024 sc1 lds
  buffer_load_dwordx4 v3, s[12:15], s62 offen offset:2048 sc1 lds
  buffer_load_dwordx4 v3, s[12:15], s62 offen offset:3072 sc1 lds
  s_add_u32 m0, s60, 4096
  s_add_u32 s62, s40, 4096
  buffer_load_dwordx4 v3, s[12:15], s62 offen offset:0 sc1 lds
  buffer_load_dwordx4 v3, s[12:15], s62 offen offset:1024 sc1 lds
  buffer_load_dwordx4 v3, s[12:15], s62 offen offset:2048 sc1 lds
  buffer_load_dwordx4 v3, s[12:15], s62 offen offset:3072 sc1 lds
  s_add_u32 m0, s60, 8192
  s_add_u32 s62, s40, 8192
  buffer_load_dwordx4 v3, s[12:15], s62 offen offset:0 sc1 lds
  s_add_u32 s40, s40, 36864
  s_add_u32 s39, s39, 36864
  s_cmp_eq_u32 s39, 147456
  s_cselect_b32 s39, 0, s39
  s_add_u32 s60, s58, s39
  s_add_u32 m0, s60, 0
  s_add_u32 s62, s40, 0
  buffer_load_dwordx4 v3, s[12:15], s62 offen offset:0 sc1 lds
  buffer_load_dwordx4 v3, s[12:15], s62 offen offset:1024 sc1 lds
  buffer_load_dwordx4 v3, s[12:15], s62 offen offset:2048 sc1 lds
  buffer_load_dwordx4 v3, s[12:15], s62 offen offset:3072 sc1 lds
  s_add_u32 m0, s60, 4096
  s_add_u32 s62, s40, 4096
  buffer_load_dwordx4 v3, s[12:15], s62 offen offset:0 sc1 lds
  buffer_load_dwordx4 v3, s[12:15], s62 offen offset:1024 sc1 lds
  buffer_load_dwordx4 v3, s[12:15], s62 offen offset:2048 sc1 lds
  buffer_load_dwordx4 v3, s[12:15], s62 offen offset:3072 sc1 lds
  s_add_u32 m0, s60, 8192
  s_add_u32 s62, s40, 8192
  buffer_load_dwordx4 v3, s[12:15], s62 offen offset:0 sc1 lds
  s_add_u32 s40, s40, 36864
  s_add_u32 s39, s39, 36864
  s_cmp_eq_u32 s39, 147456
  s_cselect_b32 s39, 0, s39
  s_add_u32 s60, s58, s39
  s_mov_b64 exec, 1
K3_POLL2:
  buffer_load_dword v10, v9, s[24:27], s56 offen sc1
  s_add_u32 s59, s59, 1
  s_waitcnt vmcnt(0)
  v_cmp_gt_u32 vcc, 32, v10
  s_cmp_ge_u32 s59, 0x8000
  s_cbranch_scc1 K3_GO2
  s_cbranch_vccz K3_GO2
  s_sleep 8
  s_branch K3_POLL2
K3_GO2:
  s_mov_b64 exec, -1
  buffer_load_dwordx4 v[112:115], v3, s[8:11], s55 offen offset:0 sc1
  buffer_load_dwordx4 v[116:119], v3, s[8:11], s55 offen offset:1024 sc1
  buffer_load_dwordx4 v[120:123], v3, s[8:11], s55 offen offset:2048 sc1
  buffer_load_dwordx4 v[124:127], v3, s[8:11], s55 offen offset:3072 sc1
  s_add_u32 s55, s55, 4096
  buffer_load_dwordx4 v[128:131], v3, s[8:11], s55 offen offset:0 sc1
  buffer_load_dwordx4 v[132:135], v3, s[8:11], s55 offen offset:1024 sc1
  buffer_load_dwordx4 v[136:139], v3, s[8:11], s55 offen offset:2048 sc1
  buffer_load_dwordx4 v[140:143], v3, s[8:11], s55 offen offset:3072 sc1
  s_add_u32 s55, s55, 4096
  buffer_load_dwordx4 v[144:147], v3, s[8:11], s55 offen offset:0 sc1
  buffer_load_dwordx4 v[148:151], v3, s[8:11], s55 offen offset:1024 sc1
  buffer_load_dwordx4 v[152:155], v3, s[8:11], s55 offen offset:2048 sc1
  buffer_load_dwordx4 v[156:159], v3, s[8:11], s55 offen offset:3072 sc1
  s_add_u32 s55, s55, 4096
  buffer_load_dwordx4 v[160:163], v3, s[8:11], s55 offen offset:0 sc1
  buffer_load_dwordx4 v[164:167], v3, s[8:11], s55 offen offset:1024 sc1
  buffer_load_dwordx4 v[168:171], v3, s[8:11], s55 offen offset:2048 sc1
  buffer_load_dwordx4 v[172:175], v3, s[8:11], s55 offen offset:3072 sc1
  s_add_u32 s55, s55, 4096
  buffer_load_dwordx4 v[176:179], v3, s[8:11], s55 offen offset:0 sc1
  buffer_load_dwordx4 v[180:183], v3, s[8:11], s55 offen offset:1024 sc1
  buffer_load_dwordx4 v[184:187], v3, s[8:11], s55 offen offset:2048 sc1
  buffer_load_dwordx4 v[188:191], v3, s[8:11], s55 offen offset:3072 sc1
  s_add_u32 s55, s55, 4096
  buffer_load_dwordx4 v[192:195], v3, s[8:11], s55 offen offset:0 sc1
  buffer_load_dwordx4 v[196:199], v3, s[8:11], s55 offen offset:1024 sc1
  buffer_load_dwordx4 v[200:203], v3, s[8:11], s55 offen offset:2048 sc1
  buffer_load_dwordx4 v[204:207], v3, s[8:11], s55 offen offset:3072 sc1
  s_add_u32 s55, s55, 4096
  buffer_load_dwordx4 v[208:211], v3, s[8:11], s55 offen offset:0 sc1
  buffer_load_dwordx4 v[212:215], v3, s[8:11], s55 offen offset:1024 sc1
  buffer_load_dwordx4 v[216:219], v3, s[8:11], s55 offen offset:2048 sc1
  buffer_load_dwordx4 v[220:223], v3, s[8:11], s55 offen offset:3072 sc1
  s_add_u32 s55, s55, 4096
  buffer_load_dwordx4 v[224:227], v3, s[8:11], s55 offen offset:0 sc1
  buffer_load_dwordx4 v[228:231], v3, s[8:11], s55 offen offset:1024 sc1
  buffer_load_dwordx4 v[232:235], v3, s[8:11], s55 offen offset:2048 sc1
  buffer_load_dwordx4 v[236:239], v3, s[8:11], s55 offen offset:3072 sc1
  s_add_u32 s55, s55, 4096
  buffer_load_dwordx4 v[240:243], v3, s[8:11], s55 offen offset:0 sc1
  buffer_load_dwordx4 v[244:247], v3, s[8:11], s55 offen offset:1024 sc1
  buffer_load_dwordx4 v[248:251], v3, s[8:11], s55 offen offset:2048 sc1
  buffer_load_dwordx4 v[252:255], v3, s[8:11], s55 offen offset:3072 sc1
  s_add_u32 s55, s55, 4096
  s_waitcnt vmcnt(36)
  s_branch K3_RDY
K3_XF:
  s_mov_b64 exec, -1
  buffer_load_dwordx4 v[112:115], v3, s[8:11], s55 offen offset:0 sc1
  buffer_load_dwordx4 v[116:119], v3, s[8:11], s55 offen offset:1024 sc1
  buffer_load_dwordx4 v[120:123], v3, s[8:11], s55 offen offset:2048 sc1
  buffer_load_dwordx4 v[124:127], v3, s[8:11], s55 offen offset:3072 sc1
  s_add_u32 s55, s55, 4096
  buffer_load_dwordx4 v[128:131], v3, s[8:11], s55 offen offset:0 sc1
  buffer_load_dwordx4 v[132:135], v3, s[8:11], s55 offen offset:1024 sc1
  buffer_load_dwordx4 v[136:139], v3, s[8:11], s55 offen offset:2048 sc1
  buffer_load_dwordx4 v[140:143], v3, s[8:11], s55 offen offset:3072 sc1
  s_add_u32 s55, s55, 4096
  buffer_load_dwordx4 v[144:147], v3, s[8:11], s55 offen offset:0 sc1
  buffer_load_dwordx4 v[148:151], v3, s[8:11], s55 offen offset:1024 sc1
  buffer_load_dwordx4 v[152:155], v3, s[8:11], s55 offen offset:2048 sc1
  buffer_load_dwordx4 v[156:159], v3, s[8:11], s55 offen offset:3072 sc1
  s_add_u32 s55, s55, 4096
  buffer_load_dwordx4 v[160:163], v3, s[8:11], s55 offen offset:0 sc1
  buffer_load_dwordx4 v[164:167], v3, s[8:11], s55 offen offset:1024 sc1
  buffer_load_dwordx4 v[168:171], v3, s[8:11], s55 offen offset:2048 sc1
  buffer_load_dwordx4 v[172:175], v3, s[8:11], s55 offen offset:3072 sc1
  s_add_u32 s55, s55, 4096
  buffer_load_dwordx4 v[176:179], v3, s[8:11], s55 offen offset:0 sc1
  buffer_load_dwordx4 v[180:183], v3, s[8:11], s55 offen offset:1024 sc1
  buffer_load_dwordx4 v[184:187], v3, s[8:11], s55 offen offset:2048 sc1
  buffer_load_dwordx4 v[188:191], v3, s[8:11], s55 offen offset:3072 sc1
  s_add_u32 s55, s55, 4096
  buffer_load_dwordx4 v[192:195], v3, s[8:11], s55 offen offset:0 sc1
  buffer_load_dwordx4 v[196:199], v3, s[8:11], s55 offen offset:1024 sc1
  buffer_load_dwordx4 v[200:203], v3, s[8:11], s55 offen offset:2048 sc1
  buffer_load_dwordx4 v[204:207], v3, s[8:11], s55 offen offset:3072 sc1
  s_add_u32 s55, s55, 4096
  buffer_load_dwordx4 v[208:211], v3, s[8:11], s55 offen offset:0 sc1
  buffer_load_dwordx4 v[212:215], v3, s[8:11], s55 offen offset:1024 sc1
  buffer_load_dwordx4 v[216:219], v3, s[8:11], s55 offen offset:2048 sc1
  buffer_load_dwordx4 v[220:223], v3, s[8:11], s55 offen offset:3072 sc1
  s_add_u32 s55, s55, 4096
  buffer_load_dwordx4 v[224:227], v3, s[8:11], s55 offen offset:0 sc1
  buffer_load_dwordx4 v[228:231], v3, s[8:11], s55 offen offset:1024 sc1
  buffer_load_dwordx4 v[232:235], v3, s[8:11], s55 offen offset:2048 sc1
  buffer_load_dwordx4 v[236:239], v3, s[8:11], s55 offen offset:3072 sc1
  s_add_u32 s55, s55, 4096
  buffer_load_dwordx4 v[240:243], v3, s[8:11], s55 offen offset:0 sc1
  buffer_load_dwordx4 v[244:247], v3, s[8:11], s55 offen offset:1024 sc1
  buffer_load_dwordx4 v[248:251], v3, s[8:11], s55 offen offset:2048 sc1
  buffer_load_dwordx4 v[252:255], v3, s[8:11], s55 offen offset:3072 sc1
  s_add_u32 s55, s55, 4096
  v_mov_b32 v8, 153600
K3_LSPIN1:
  ds_read_b32 v10, v8
  s_waitcnt lgkmcnt(0)
  v_readfirstlane_b32 s61, v10
  s_nop 0
  s_cmp_ge_u32 s61, 4
  s_cbranch_scc1 K3_LGO1
  s_sleep 4
  s_branch K3_LSPIN1
K3_LGO1:
  s_add_u32 s60, s58, s39
  s_add_u32 m0, s60, 0
  s_add_u32 s62, s40, 0
  buffer_load_dwordx4 v3, s[12:15], s62 offen offset:0 sc1 lds
  buffer_load_dwordx4 v3, s[12:15], s62 offen offset:1024 sc1 lds
  buffer_load_dwordx4 v3, s[12:15], s62 offen offset:2048 sc1 lds
  buffer_load_dwordx4 v3, s[12:15], s62 offen offset:3072 sc1 lds
  s_add_u32 m0, s60, 4096
  s_add_u32 s62, s40, 4096
  buffer_load_dwordx4 v3, s[12:15], s62 offen offset:0 sc1 lds
  buffer_load_dwordx4 v3, s[12:15], s62 offen offset:1024 sc1 lds
  buffer_load_dwordx4 v3, s[12:15], s62 offen offset:2048 sc1 lds
  buffer_load_dwordx4 v3, s[12:15], s62 offen offset:3072 sc1 lds
  s_add_u32 m0, s60, 8192
  s_add_u32 s62, s40, 8192
  buffer_load_dwordx4 v3, s[12:15], s62 offen offset:0 sc1 lds
  s_add_u32 s40, s40, 36864
  s_add_u32 s39, s39, 36864
  s_cmp_eq_u32 s39, 147456
  s_cselect_b32 s39, 0, s39
  s_add_u32 s60, s58, s39
  s_add_u32 m0, s60, 0
  s_add_u32 s62, s40, 0
  buffer_load_dwordx4 v3, s[12:15], s62 offen offset:0 sc1 lds
  buffer_load_dwordx4 v3, s[12:15], s62 offen offset:1024 sc1 lds
  buffer_load_dwordx4 v3, s[12:15], s62 offen offset:2048 sc1 lds
  buffer_load_dwordx4 v3, s[12:15], s62 offen offset:3072 sc1 lds
  s_add_u32 m0, s60, 4096
  s_add_u32 s62, s40, 4096
  buffer_load_dwordx4 v3, s[12:15], s62 offen offset:0 sc1 lds
  buffer_load_dwordx4 v3, s[12:15], s62 offen offset:1024 sc1 lds
  buffer_load_dwordx4 v3, s[12:15], s62 offen offset:2048 sc1 lds
  buffer_load_dwordx4 v3, s[12:15], s62 offen offset:3072 sc1 lds
  s_add_u32 m0, s60, 8192
  s_add_u32 s62, s40, 8192
  buffer_load_dwordx4 v3, s[12:15], s62 offen offset:0 sc1 lds
  s_add_u32 s40, s40, 36864
  s_add_u32 s39, s39, 36864
  s_cmp_eq_u32 s39, 147456
  s_cselect_b32 s39, 0, s39
  s_add_u32 s60, s58, s39
  s_add_u32 m0, s60, 0
  s_add_u32 s62, s40, 0
  buffer_load_dwordx4 v3, s[12:15], s62 offen offset:0 sc1 lds
  buffer_load_dwordx4 v3, s[12:15], s62 offen offset:1024 sc1 lds
  buffer_load_dwordx4 v3, s[12:15], s62 offen offset:2048 sc1 lds
  buffer_load_dwordx4 v3, s[12:15], s62 offen offset:3072 sc1 lds
  s_add_u32 m0, s60, 4096
  s_add_u32 s62, s40, 4096
  buffer_load_dwordx4 v3, s[12:15], s62 offen offset:0 sc1 lds
  buffer_load_dwordx4 v3, s[12:15], s62 offen offset:1024 sc1 lds
  buffer_load_dwordx4 v3, s[12:15], s62 offen offset:2048 sc1 lds
  buffer_load_dwordx4 v3, s[12:15], s62 offen offset:3072 sc1 lds
  s_add_u32 m0, s60, 8192
  s_add_u32 s62, s40, 8192
  buffer_load_dwordx4 v3, s[12:15], s62 offen offset:0 sc1 lds
  s_add_u32 s40, s40, 36864
  s_add_u32 s39, s39, 36864
  s_cmp_eq_u32 s39, 147456
  s_cselect_b32 s39, 0, s39
  s_add_u32 s60, s58, s39
  s_waitcnt vmcnt(18)
K3_RDY:
  s_add_u32 s16, s4, 33554432
  s_addc_u32 s17, s5, 0
  s_mov_b32 s18, 21233664
  s_mov_b32 s19, 0x20000
  s_lshr_b32 s52, s50, 2
  s_lshl_b32 s52, s52, 2
  s_lshr_b32 s54, s51, 3
  s_add_u32 s52, s52, s54
  s_mul_i32 s52, s52, 746496
  s_add_u32 s66, s4, s52
  s_addc_u32 s67, s5, 0
  s_add_u32 s66, s66, 25165824
  s_addc_u32 s67, s67, 0
  s_mov_b32 s65, s58
  s_lshl_b32 s64, s37, 7
  s_mul_i32 s41, s53, 331776
  s_mul_i32 s54, s38, 9216
  s_add_u32 s41, s41, s54
  s_add_u32 s41, s41, 18432
  v_bfe_u32 v6, v1, 4, 1
  v_mul_u32_u24 v6, 165888, v6
  v_and_b32 v7, 15, v1
  v_lshl_add_u32 v6, v7, 4, v6
  v_lshrrev_b32 v7, 5, v1
  v_lshl_add_u32 v4, v7, 8, v6
  s_mov_b32 s54, 3184710632
  v_mov_b32 v5, 3222493025
  s_mov_b32 s42, 0
  s_mov_b32 s63, 36864
  s_barrier
  ds_read_b128 v[16:19], v2 offset:0
  ds_read_b128 v[20:23], v2 offset:1024
  ds_read_b128 v[24:27], v2 offset:2048
  ds_read_b128 v[28:31], v2 offset:3072
  ds_read_b128 v[32:35], v2 offset:4096
  ds_read_b128 v[36:39], v2 offset:5120
  ds_read_b128 v[40:43], v2 offset:6144
  ds_read_b128 v[44:47], v2 offset:7168
  ds_read_b128 v[48:51], v2 offset:8192
  ds_read_b128 v[52:55], v2 offset:9216
  ds_read_b128 v[56:59], v2 offset:10240
  ds_read_b128 v[60:63], v2 offset:11264
  s_waitcnt vmcnt(35)
  s_waitcnt lgkmcnt(11)
  v_mfma_f32_32x32x16_bf16 v[64:79], v[16:19], v[112:115], 0
  ds_read_b128 v[16:19], v2 offset:12288
  s_waitcnt vmcnt(34)
  s_waitcnt lgkmcnt(11)
  v_mfma_f32_32x32x16_bf16 v[64:79], v[20:23], v[116:119], v[64:79]
  ds_read_b128 v[20:23], v2 offset:13312
  s_waitcnt vmcnt(33)
  s_waitcnt lgkmcnt(11)
  v_mfma_f32_32x32x16_bf16 v[64:79], v[24:27], v[120:123], v[64:79]
  ds_read_b128 v[24:27], v2 offset:14336
  s_waitcnt vmcnt(32)
  s_waitcnt lgkmcnt(11)
  v_mfma_f32_32x32x16_bf16 v[64:79], v[28:31], v[124:127], v[64:79]
  ds_read_b128 v[28:31], v2 offset:15360
  s_waitcnt vmcnt(31)
  s_waitcnt lgkmcnt(11)
  v_mfma_f32_32x32x16_bf16 v[64:79], v[32:35], v[128:131], v[64:79]
  ds_read_b128 v[32:35], v2 offset:16384
  s_waitcnt vmcnt(30)
  s_waitcnt lgkmcnt(11)
  v_mfma_f32_32x32x16_bf16 v[64:79], v[36:39], v[132:135], v[64:79]
  ds_read_b128 v[36:39], v2 offset:17408
  s_waitcnt vmcnt(29)
  s_waitcnt lgkmcnt(11)
  v_mfma_f32_32x32x16_bf16 v[64:79], v[40:43], v[136:139], v[64:79]
  ds_read_b128 v[40:43], v2 offset:18432
  s_waitcnt vmcnt(28)
  s_waitcnt lgkmcnt(11)
  v_mfma_f32_32x32x16_bf16 v[64:79], v[44:47], v[140:143], v[64:79]
  ds_read_b128 v[44:47], v2 offset:19456
  s_waitcnt vmcnt(27)
  s_waitcnt lgkmcnt(11)
  v_mfma_f32_32x32x16_bf16 v[64:79], v[48:51], v[144:147], v[64:79]
  ds_read_b128 v[48:51], v2 offset:20480
  s_waitcnt vmcnt(26)
  s_waitcnt lgkmcnt(11)
  v_mfma_f32_32x32x16_bf16 v[64:79], v[52:55], v[148:151], v[64:79]
  ds_read_b128 v[52:55], v2 offset:21504
  s_waitcnt vmcnt(25)
  s_waitcnt lgkmcnt(11)
  v_mfma_f32_32x32x16_bf16 v[64:79], v[56:59], v[152:155], v[64:79]
  ds_read_b128 v[56:59], v2 offset:22528
  s_waitcnt vmcnt(24)
  s_waitcnt lgkmcnt(11)
  v_mfma_f32_32x32x16_bf16 v[64:79], v[60:63], v[156:159], v[64:79]
  ds_read_b128 v[60:63], v2 offset:23552
  s_waitcnt vmcnt(23)
  s_waitcnt lgkmcnt(11)
  v_mfma_f32_32x32x16_bf16 v[64:79], v[16:19], v[160:163], v[64:79]
  ds_read_b128 v[16:19], v2 offset:24576
  s_waitcnt vmcnt(22)
  s_waitcnt lgkmcnt(11)
  v_mfma_f32_32x32x16_bf16 v[64:79], v[20:23], v[164:167], v[64:79]
  ds_read_b128 v[20:23], v2 offset:25600
  s_waitcnt vmcnt(21)
  s_waitcnt lgkmcnt(11)
  v_mfma_f32_32x32x16_bf16 v[64:79], v[24:27], v[168:171], v[64:79]
  ds_read_b128 v[24:27], v2 offset:26624
  s_waitcnt vmcnt(20)
  s_waitcnt lgkmcnt(11)
  v_mfma_f32_32x32x16_bf16 v[64:79], v[28:31], v[172:175], v[64:79]
  ds_read_b128 v[28:31], v2 offset:27648
  s_waitcnt vmcnt(19)
  s_waitcnt lgkmcnt(11)
  v_mfma_f32_32x32x16_bf16 v[64:79], v[32:35], v[176:179], v[64:79]
  ds_read_b128 v[32:35], v2 offset:28672
  s_waitcnt vmcnt(18)
  s_waitcnt lgkmcnt(11)
  v_mfma_f32_32x32x16_bf16 v[64:79], v[36:39], v[180:183], v[64:79]
  ds_read_b128 v[36:39], v2 offset:29696
  s_waitcnt vmcnt(17)
  s_waitcnt lgkmcnt(11)
  v_mfma_f32_32x32x16_bf16 v[64:79], v[40:43], v[184:187], v[64:79]
  ds_read_b128 v[40:43], v2 offset:30720
  s_waitcnt vmcnt(16)
  s_waitcnt lgkmcnt(11)
  v_mfma_f32_32x32x16_bf16 v[64:79], v[44:47], v[188:191], v[64:79]
  ds_read_b128 v[44:47], v2 offset:31744
  s_waitcnt vmcnt(15)
  s_waitcnt lgkmcnt(11)
  v_mfma_f32_32x32x16_bf16 v[64:79], v[48:51], v[192:195], v[64:79]
  ds_read_b128 v[48:51], v2 offset:32768
  s_waitcnt vmcnt(14)
  s_waitcnt lgkmcnt(11)
  v_mfma_f32_32x32x16_bf16 v[64:79], v[52:55], v[196:199], v[64:79]
  ds_read_b128 v[52:55], v2 offset:33792
  s_waitcnt vmcnt(13)
  s_waitcnt lgkmcnt(11)
  v_mfma_f32_32x32x16_bf16 v[64:79], v[56:59], v[200:203], v[64:79]
  ds_read_b128 v[56:59], v2 offset:34816
  s_waitcnt vmcnt(12)
  s_waitcnt lgkmcnt(11)
  v_mfma_f32_32x32x16_bf16 v[64:79], v[60:63], v[204:207], v[64:79]
  ds_read_b128 v[60:63], v2 offset:35840
  s_waitcnt vmcnt(11)
  s_waitcnt lgkmcnt(11)
  v_mfma_f32_32x32x16_bf16 v[64:79], v[16:19], v[208:211], v[64:79]
  s_waitcnt vmcnt(9)
  s_barrier
  s_add_u32 s42, s42, 1
  s_and_b32 s53, s42, 3
  s_cmp_eq_u32 s53, 0
  s_cselect_b32 s53, 4294856704, s63
  v_add_u32 v2, s53, v2
  ds_read_b128 v[16:19], v2 offset:0
  s_waitcnt vmcnt(10)
  s_waitcnt lgkmcnt(11)
  v_mfma_f32_32x32x16_bf16 v[64:79], v[20:23], v[212:215], v[64:79]
  ds_read_b128 v[20:23], v2 offset:1024
  s_waitcnt vmcnt(9)
  s_waitcnt lgkmcnt(11)
  v_mfma_f32_32x32x16_bf16 v[64:79], v[24:27], v[216:219], v[64:79]
  ds_read_b128 v[24:27], v2 offset:2048
  s_waitcnt vmcnt(8)
  s_waitcnt lgkmcnt(11)
  v_mfma_f32_32x32x16_bf16 v[64:79], v[28:31], v[220:223], v[64:79]
  ds_read_b128 v[28:31], v2 offset:3072
  s_waitcnt vmcnt(7)
  s_waitcnt lgkmcnt(11)
  v_mfma_f32_32x32x16_bf16 v[64:79], v[32:35], v[224:227], v[64:79]
  ds_read_b128 v[32:35], v2 offset:4096
  s_add_u32 m0, s60, 0
  s_add_u32 s62, s40, 0
  buffer_load_dwordx4 v3, s[12:15], s62 offen offset:0 sc1 lds
  s_waitcnt vmcnt(7)
  s_waitcnt lgkmcnt(11)
  v_mfma_f32_32x32x16_bf16 v[64:79], v[36:39], v[228:231], v[64:79]
  ds_read_b128 v[36:39], v2 offset:5120
  s_waitcnt vmcnt(6)
  s_waitcnt lgkmcnt(11)
  v_mfma_f32_32x32x16_bf16 v[64:79], v[40:43], v[232:235], v[64:79]
  ds_read_b128 v[40:43], v2 offset:6144
  s_waitcnt vmcnt(5)
  s_waitcnt lgkmcnt(11)
  v_mfma_f32_32x32x16_bf16 v[64:79], v[44:47], v[236:239], v[64:79]
  ds_read_b128 v[44:47], v2 offset:7168
  buffer_load_dwordx4 v3, s[12:15], s62 offen offset:1024 sc1 lds
  s_waitcnt vmcnt(5)
  s_waitcnt lgkmcnt(11)
  v_mfma_f32_32x32x16_bf16 v[64:79], v[48:51], v[240:243], v[64:79]
  ds_read_b128 v[48:51], v2 offset:8192
  s_waitcnt vmcnt(4)
  s_waitcnt lgkmcnt(11)
  v_mfma_f32_32x32x16_bf16 v[64:79], v[52:55], v[244:247], v[64:79]
  ds_read_b128 v[52:55], v2 offset:9216
  s_waitcnt vmcnt(3)
  s_waitcnt lgkmcnt(11)
  v_mfma_f32_32x32x16_bf16 v[64:79], v[56:59], v[248:251], v[64:79]
  ds_read_b128 v[56:59], v2 offset:10240
  buffer_load_dwordx4 v3, s[12:15], s62 offen offset:2048 sc1 lds
  s_waitcnt vmcnt(3)
  s_waitcnt lgkmcnt(11)
  v_mfma_f32_32x32x16_bf16 v[64:79], v[60:63], v[252:255], v[64:79]
  ds_read_b128 v[60:63], v2 offset:11264
K3_LOOP:
  s_waitcnt lgkmcnt(11)
  v_mfma_f32_32x32x16_bf16 v[80:95], v[16:19], v[112:115], 0
  ds_read_b128 v[16:19], v2 offset:12288
  buffer_load_dwordx4 v3, s[12:15], s62 offen offset:3072 sc1 lds
  s_waitcnt lgkmcnt(11)
  v_mfma_f32_32x32x16_bf16 v[80:95], v[20:23], v[116:119], v[80:95]
  ds_read_b128 v[20:23], v2 offset:13312
  s_waitcnt lgkmcnt(11)
  v_mfma_f32_32x32x16_bf16 v[80:95], v[24:27], v[120:123], v[80:95]
  ds_read_b128 v[24:27], v2 offset:14336
  s_nop 0
  v_mul_f32 v96, v64, v64
  v_mul_f32 v97, v65, v65
  v_mul_f32 v98, v66, v66
  v_mul_f32 v99, v67, v67
  s_waitcnt lgkmcnt(11)
  v_mfma_f32_32x32x16_bf16 v[80:95], v[28:31], v[124:127], v[80:95]
  ds_read_b128 v[28:31], v2 offset:15360
  v_mul_f32 v100, v68, v68
  v_mul_f32 v101, v69, v69
  v_mul_f32 v102, v70, v70
  v_mul_f32 v103, v71, v71
  s_waitcnt lgkmcnt(11)
  v_mfma_f32_32x32x16_bf16 v[80:95], v[32:35], v[128:131], v[80:95]
  ds_read_b128 v[32:35], v2 offset:16384
  s_add_u32 m0, s60, 4096
  s_add_u32 s62, s40, 4096
  buffer_load_dwordx4 v3, s[12:15], s62 offen offset:0 sc1 lds
  v_fma_f32 v96, v96, s54, v5
  v_fma_f32 v97, v97, s54, v5
  v_fma_f32 v98, v98, s54, v5
  v_fma_f32 v99, v99, s54, v5
  s_waitcnt lgkmcnt(11)
  v_mfma_f32_32x32x16_bf16 v[80:95], v[36:39], v[132:135], v[80:95]
  ds_read_b128 v[36:39], v2 offset:17408
  v_fma_f32 v100, v100, s54, v5
  v_fma_f32 v101, v101, s54, v5
  v_fma_f32 v102, v102, s54, v5
  s_waitcnt lgkmcnt(11)
  v_mfma_f32_32x32x16_bf16 v[80:95], v[40:43], v[136:139], v[80:95]
  ds_read_b128 v[40:43], v2 offset:18432
  v_fma_f32 v103, v103, s54, v5
  v_mul_f32 v96, v96, v64
  v_mul_f32 v97, v97, v65
  v_mul_f32 v98, v98, v66
  s_waitcnt lgkmcnt(11)
  v_mfma_f32_32x32x16_bf16 v[80:95], v[44:47], v[140:143], v[80:95]
  ds_read_b128 v[44:47], v2 offset:19456
  v_mul_f32 v99, v99, v67
  v_mul_f32 v100, v100, v68
  v_mul_f32 v101, v101, v69
  v_mul_f32 v102, v102, v70
  s_waitcnt lgkmcnt(11)
  v_mfma_f32_32x32x16_bf16 v[80:95], v[48:51], v[144:147], v[80:95]
  ds_read_b128 v[48:51], v2 offset:20480
  buffer_load_dwordx4 v3, s[12:15], s62 offen offset:1024 sc1 lds
  v_mul_f32 v103, v103, v71
  v_exp_f32 v96, v96
  v_exp_f32 v97, v97
  v_exp_f32 v98, v98
  s_waitcnt lgkmcnt(11)
  v_mfma_f32_32x32x16_bf16 v[80:95], v[52:55], v[148:151], v[80:95]
  ds_read_b128 v[52:55], v2 offset:21504
  v_exp_f32 v99, v99
  v_exp_f32 v100, v100
  v_exp_f32 v101, v101
  s_waitcnt lgkmcnt(11)
  v_mfma_f32_32x32x16_bf16 v[80:95], v[56:59], v[152:155], v[80:95]
  ds_read_b128 v[56:59], v2 offset:22528
  v_exp_f32 v102, v102
  v_exp_f32 v103, v103
  v_add_f32 v96, 1.0, v96
  v_add_f32 v97, 1.0, v97
  s_waitcnt lgkmcnt(11)
  v_mfma_f32_32x32x16_bf16 v[80:95], v[60:63], v[156:159], v[80:95]
  ds_read_b128 v[60:63], v2 offset:23552
  v_add_f32 v98, 1.0, v98
  v_add_f32 v99, 1.0, v99
  v_add_f32 v100, 1.0, v100
  v_add_f32 v101, 1.0, v101
  s_waitcnt lgkmcnt(11)
  v_mfma_f32_32x32x16_bf16 v[80:95], v[16:19], v[160:163], v[80:95]
  ds_read_b128 v[16:19], v2 offset:24576
  buffer_load_dwordx4 v3, s[12:15], s62 offen offset:2048 sc1 lds
  v_add_f32 v102, 1.0, v102
  v_add_f32 v103, 1.0, v103
  v_rcp_f32 v96, v96
  v_rcp_f32 v97, v97
  s_waitcnt lgkmcnt(11)
  v_mfma_f32_32x32x16_bf16 v[80:95], v[20:23], v[164:167], v[80:95]
  ds_read_b128 v[20:23], v2 offset:25600
  v_rcp_f32 v98, v98
  v_rcp_f32 v99, v99
  v_rcp_f32 v100, v100
  s_waitcnt lgkmcnt(11)
  v_mfma_f32_32x32x16_bf16 v[80:95], v[24:27], v[168:171], v[80:95]
  ds_read_b128 v[24:27], v2 offset:26624
  v_rcp_f32 v101, v101
  v_rcp_f32 v102, v102
  v_rcp_f32 v103, v103
  v_mul_f32 v64, v64, v96
  s_waitcnt lgkmcnt(11)
  v_mfma_f32_32x32x16_bf16 v[80:95], v[28:31], v[172:175], v[80:95]
  ds_read_b128 v[28:31], v2 offset:27648
  v_mul_f32 v65, v65, v97
  v_mul_f32 v66, v66, v98
  v_mul_f32 v67, v67, v99
  v_mul_f32 v68, v68, v100
  s_waitcnt lgkmcnt(11)
  v_mfma_f32_32x32x16_bf16 v[80:95], v[32:35], v[176:179], v[80:95]
  ds_read_b128 v[32:35], v2 offset:28672
  buffer_load_dwordx4 v3, s[12:15], s62 offen offset:3072 sc1 lds
  v_mul_f32 v69, v69, v101
  v_mul_f32 v70, v70, v102
  v_mul_f32 v71, v71, v103
  v_cvt_pk_bf16_f32 v104, v64, v65
  s_waitcnt lgkmcnt(11)
  v_mfma_f32_32x32x16_bf16 v[80:95], v[36:39], v[180:183], v[80:95]
  ds_read_b128 v[36:39], v2 offset:29696
  v_cvt_pk_bf16_f32 v105, v66, v67
  v_cvt_pk_bf16_f32 v106, v68, v69
  v_cvt_pk_bf16_f32 v107, v70, v71
  s_waitcnt lgkmcnt(11)
  v_mfma_f32_32x32x16_bf16 v[80:95], v[40:43], v[184:187], v[80:95]
  ds_read_b128 v[40:43], v2 offset:30720
  v_mul_f32 v96, v72, v72
  v_mul_f32 v97, v73, v73
  v_mul_f32 v98, v74, v74
  v_mul_f32 v99, v75, v75
  s_waitcnt lgkmcnt(11)
  v_mfma_f32_32x32x16_bf16 v[80:95], v[44:47], v[188:191], v[80:95]
  ds_read_b128 v[44:47], v2 offset:31744
  v_mul_f32 v100, v76, v76
  v_mul_f32 v101, v77, v77
  v_mul_f32 v102, v78, v78
  v_mul_f32 v103, v79, v79
  s_waitcnt lgkmcnt(11)
  v_mfma_f32_32x32x16_bf16 v[80:95], v[48:51], v[192:195], v[80:95]
  ds_read_b128 v[48:51], v2 offset:32768
  s_add_u32 m0, s60, 8192
  s_add_u32 s62, s40, 8192
  buffer_load_dwordx4 v3, s[12:15], s62 offen offset:0 sc1 lds
  v_fma_f32 v96, v96, s54, v5
  v_fma_f32 v97, v97, s54, v5
  v_fma_f32 v98, v98, s54, v5
  v_fma_f32 v99, v99, s54, v5
  s_waitcnt lgkmcnt(11)
  v_mfma_f32_32x32x16_bf16 v[80:95], v[52:55], v[196:199], v[80:95]
  ds_read_b128 v[52:55], v2 offset:33792
  v_fma_f32 v100, v100, s54, v5
  v_fma_f32 v101, v101, s54, v5
  v_fma_f32 v102, v102, s54, v5
  s_waitcnt lgkmcnt(11)
  v_mfma_f32_32x32x16_bf16 v[80:95], v[56:59], v[200:203], v[80:95]
  ds_read_b128 v[56:59], v2 offset:34816
  v_fma_f32 v103, v103, s54, v5
  v_mul_f32 v96, v96, v72
  v_mul_f32 v97, v97, v73
  v_mul_f32 v98, v98, v74
  s_waitcnt lgkmcnt(11)
  v_mfma_f32_32x32x16_bf16 v[80:95], v[60:63], v[204:207], v[80:95]
  ds_read_b128 v[60:63], v2 offset:35840
  v_mul_f32 v99, v99, v75
  v_mul_f32 v100, v100, v76
  v_mul_f32 v101, v101, v77
  v_mul_f32 v102, v102, v78
  s_waitcnt lgkmcnt(11)
  v_mfma_f32_32x32x16_bf16 v[80:95], v[16:19], v[208:211], v[80:95]
  s_waitcnt vmcnt(9)
  s_cmp_eq_u32 s36, 0
  s_cbranch_scc0 K3_W4X
  s_cmp_eq_u32 s42, 5
  s_cbranch_scc0 K3_W4A
K3_W4P:
  v_readfirstlane_b32 s61, v11
  s_add_u32 s59, s59, 1
  s_cmp_ge_u32 s61, 54
  s_cbranch_scc1 K3_W4X
  s_cmp_ge_u32 s59, 0x20000
  s_cbranch_scc1 K3_W4X
  s_mov_b64 exec, 1
  buffer_load_dword v11, v9, s[24:27], s70 offen sc1
  s_mov_b64 exec, -1
  s_waitcnt vmcnt(0)
  s_branch K3_W4P
K3_W4A:
  s_mov_b64 exec, 1
  buffer_load_dword v11, v9, s[24:27], s70 offen sc1
  s_mov_b64 exec, -1
K3_W4X:
  s_barrier
  s_add_u32 s42, s42, 1
  s_and_b32 s53, s42, 3
  s_cmp_eq_u32 s53, 0
  s_cselect_b32 s53, 4294856704, s63
  v_add_u32 v2, s53, v2
  s_add_u32 s40, s40, 36864
  s_add_u32 s39, s39, 36864
  s_cmp_eq_u32 s39, 147456
  s_cselect_b32 s39, 0, s39
  s_cmp_eq_u32 s42, 7
  s_cselect_b32 s12, s66, s12
  s_cselect_b32 s13, s67, s13
  s_cselect_b32 s14, 746496, s14
  s_cselect_b32 s40, s65, s40
  s_add_u32 s60, s58, s39
  ds_read_b128 v[16:19], v2 offset:0
  s_add_u32 m0, s60, 0
  s_add_u32 s62, s40, 0
  buffer_load_dwordx4 v3, s[12:15], s62 offen offset:0 sc1 lds
  v_mul_f32 v103, v103, v79
  v_exp_f32 v96, v96
  v_exp_f32 v97, v97
  v_exp_f32 v98, v98
  s_waitcnt lgkmcnt(11)
  v_mfma_f32_32x32x16_bf16 v[80:95], v[20:23], v[212:215], v[80:95]
  ds_read_b128 v[20:23], v2 offset:1024
  v_exp_f32 v99, v99
  v_exp_f32 v100, v100
  v_exp_f32 v101, v101
  s_waitcnt lgkmcnt(11)
  v_mfma_f32_32x32x16_bf16 v[80:95], v[24:27], v[216:219], v[80:95]
  ds_read_b128 v[24:27], v2 offset:2048
  v_exp_f32 v102, v102
  v_exp_f32 v103, v103
  v_add_f32 v96, 1.0, v96
  v_add_f32 v97, 1.0, v97
  s_waitcnt lgkmcnt(11)
  v_mfma_f32_32x32x16_bf16 v[80:95], v[28:31], v[220:223], v[80:95]
  ds_read_b128 v[28:31], v2 offset:3072
  v_add_f32 v98, 1.0, v98
  v_add_f32 v99, 1.0, v99
  v_add_f32 v100, 1.0, v100
  v_add_f32 v101, 1.0, v101
  s_waitcnt lgkmcnt(11)
  v_mfma_f32_32x32x16_bf16 v[80:95], v[32:35], v[224:227], v[80:95]
  ds_read_b128 v[32:35], v2 offset:4096
  buffer_load_dwordx4 v3, s[12:15], s62 offen offset:1024 sc1 lds
  v_add_f32 v102, 1.0, v102
  v_add_f32 v103, 1.0, v103
  v_rcp_f32 v96, v96
  v_rcp_f32 v97, v97
  s_waitcnt lgkmcnt(11)
  v_mfma_f32_32x32x16_bf16 v[80:95], v[36:39], v[228:231], v[80:95]
  ds_read_b128 v[36:39], v2 offset:5120
  v_rcp_f32 v98, v98
  v_rcp_f32 v99, v99
  v_rcp_f32 v100, v100
  s_waitcnt lgkmcnt(11)
  v_mfma_f32_32x32x16_bf16 v[80:95], v[40:43], v[232:235], v[80:95]
  ds_read_b128 v[40:43], v2 offset:6144
  v_rcp_f32 v101, v101
  v_rcp_f32 v102, v102
  v_rcp_f32 v103, v103
  v_mul_f32 v72, v72, v96
  s_waitcnt lgkmcnt(11)
  v_mfma_f32_32x32x16_bf16 v[80:95], v[44:47], v[236:239], v[80:95]
  ds_read_b128 v[44:47], v2 offset:7168
  v_mul_f32 v73, v73, v97
  v_mul_f32 v74, v74, v98
  v_mul_f32 v75, v75, v99
  v_mul_f32 v76, v76, v100
  s_waitcnt lgkmcnt(11)
  v_mfma_f32_32x32x16_bf16 v[80:95], v[48:51], v[240:243], v[80:95]
  ds_read_b128 v[48:51], v2 offset:8192
  buffer_load_dwordx4 v3, s[12:15], s62 offen offset:2048 sc1 lds
  v_mul_f32 v77, v77, v101
  v_mul_f32 v78, v78, v102
  v_mul_f32 v79, v79, v103
  v_cvt_pk_bf16_f32 v108, v72, v73
  s_waitcnt lgkmcnt(11)
  v_mfma_f32_32x32x16_bf16 v[80:95], v[52:55], v[244:247], v[80:95]
  ds_read_b128 v[52:55], v2 offset:9216
  v_cvt_pk_bf16_f32 v109, v74, v75
  v_cvt_pk_bf16_f32 v110, v76, v77
  v_cvt_pk_bf16_f32 v111, v78, v79
  s_waitcnt lgkmcnt(11)
  v_mfma_f32_32x32x16_bf16 v[80:95], v[56:59], v[248:251], v[80:95]
  ds_read_b128 v[56:59], v2 offset:10240
  buffer_store_dwordx4 v[104:107], v4, s[16:19], s41 offen offset:0 sc1
  buffer_store_dwordx4 v[108:111], v4, s[16:19], s41 offen offset:512 sc1
  s_add_u32 s41, s41, 1024
  s_waitcnt lgkmcnt(11)
  v_mfma_f32_32x32x16_bf16 v[80:95], v[60:63], v[252:255], v[80:95]
  ds_read_b128 v[60:63], v2 offset:11264
  s_waitcnt lgkmcnt(11)
  v_mfma_f32_32x32x16_bf16 v[64:79], v[16:19], v[112:115], 0
  ds_read_b128 v[16:19], v2 offset:12288
  buffer_load_dwordx4 v3, s[12:15], s62 offen offset:3072 sc1 lds
  s_waitcnt lgkmcnt(11)
  v_mfma_f32_32x32x16_bf16 v[64:79], v[20:23], v[116:119], v[64:79]
  ds_read_b128 v[20:23], v2 offset:13312
  s_waitcnt lgkmcnt(11)
  v_mfma_f32_32x32x16_bf16 v[64:79], v[24:27], v[120:123], v[64:79]
  ds_read_b128 v[24:27], v2 offset:14336
  s_nop 0
  v_mul_f32 v96, v80, v80
  v_mul_f32 v97, v81, v81
  v_mul_f32 v98, v82, v82
  v_mul_f32 v99, v83, v83
  s_waitcnt lgkmcnt(11)
  v_mfma_f32_32x32x16_bf16 v[64:79], v[28:31], v[124:127], v[64:79]
  ds_read_b128 v[28:31], v2 offset:15360
  v_mul_f32 v100, v84, v84
  v_mul_f32 v101, v85, v85
  v_mul_f32 v102, v86, v86
  v_mul_f32 v103, v87, v87
  s_waitcnt lgkmcnt(11)
  v_mfma_f32_32x32x16_bf16 v[64:79], v[32:35], v[128:131], v[64:79]
  ds_read_b128 v[32:35], v2 offset:16384
  s_add_u32 m0, s60, 4096
  s_add_u32 s62, s40, 4096
  buffer_load_dwordx4 v3, s[12:15], s62 offen offset:0 sc1 lds
  v_fma_f32 v96, v96, s54, v5
  v_fma_f32 v97, v97, s54, v5
  v_fma_f32 v98, v98, s54, v5
  v_fma_f32 v99, v99, s54, v5
  s_waitcnt lgkmcnt(11)
  v_mfma_f32_32x32x16_bf16 v[64:79], v[36:39], v[132:135], v[64:79]
  ds_read_b128 v[36:39], v2 offset:17408
  v_fma_f32 v100, v100, s54, v5
  v_fma_f32 v101, v101, s54, v5
  v_fma_f32 v102, v102, s54, v5
  s_waitcnt lgkmcnt(11)
  v_mfma_f32_32x32x16_bf16 v[64:79], v[40:43], v[136:139], v[64:79]
  ds_read_b128 v[40:43], v2 offset:18432
  v_fma_f32 v103, v103, s54, v5
  v_mul_f32 v96, v96, v80
  v_mul_f32 v97, v97, v81
  v_mul_f32 v98, v98, v82
  s_waitcnt lgkmcnt(11)
  v_mfma_f32_32x32x16_bf16 v[64:79], v[44:47], v[140:143], v[64:79]
  ds_read_b128 v[44:47], v2 offset:19456
  v_mul_f32 v99, v99, v83
  v_mul_f32 v100, v100, v84
  v_mul_f32 v101, v101, v85
  v_mul_f32 v102, v102, v86
  s_waitcnt lgkmcnt(11)
  v_mfma_f32_32x32x16_bf16 v[64:79], v[48:51], v[144:147], v[64:79]
  ds_read_b128 v[48:51], v2 offset:20480
  buffer_load_dwordx4 v3, s[12:15], s62 offen offset:1024 sc1 lds
  v_mul_f32 v103, v103, v87
  v_exp_f32 v96, v96
  v_exp_f32 v97, v97
  v_exp_f32 v98, v98
  s_waitcnt lgkmcnt(11)
  v_mfma_f32_32x32x16_bf16 v[64:79], v[52:55], v[148:151], v[64:79]
  ds_read_b128 v[52:55], v2 offset:21504
  v_exp_f32 v99, v99
  v_exp_f32 v100, v100
  v_exp_f32 v101, v101
  s_waitcnt lgkmcnt(11)
  v_mfma_f32_32x32x16_bf16 v[64:79], v[56:59], v[152:155], v[64:79]
  ds_read_b128 v[56:59], v2 offset:22528
  v_exp_f32 v102, v102
  v_exp_f32 v103, v103
  v_add_f32 v96, 1.0, v96
  v_add_f32 v97, 1.0, v97
  s_waitcnt lgkmcnt(11)
  v_mfma_f32_32x32x16_bf16 v[64:79], v[60:63], v[156:159], v[64:79]
  ds_read_b128 v[60:63], v2 offset:23552
  v_add_f32 v98, 1.0, v98
  v_add_f32 v99, 1.0, v99
  v_add_f32 v100, 1.0, v100
  v_add_f32 v101, 1.0, v101
  s_waitcnt lgkmcnt(11)
  v_mfma_f32_32x32x16_bf16 v[64:79], v[16:19], v[160:163], v[64:79]
  ds_read_b128 v[16:19], v2 offset:24576
  buffer_load_dwordx4 v3, s[12:15], s62 offen offset:2048 sc1 lds
  v_add_f32 v102, 1.0, v102
  v_add_f32 v103, 1.0, v103
  v_rcp_f32 v96, v96
  v_rcp_f32 v97, v97
  s_waitcnt lgkmcnt(11)
  v_mfma_f32_32x32x16_bf16 v[64:79], v[20:23], v[164:167], v[64:79]
  ds_read_b128 v[20:23], v2 offset:25600
  v_rcp_f32 v98, v98
  v_rcp_f32 v99, v99
  v_rcp_f32 v100, v100
  s_waitcnt lgkmcnt(11)
  v_mfma_f32_32x32x16_bf16 v[64:79], v[24:27], v[168:171], v[64:79]
  ds_read_b128 v[24:27], v2 offset:26624
  v_rcp_f32 v101, v101
  v_rcp_f32 v102, v102
  v_rcp_f32 v103, v103
  v_mul_f32 v80, v80, v96
  s_waitcnt lgkmcnt(11)
  v_mfma_f32_32x32x16_bf16 v[64:79], v[28:31], v[172:175], v[64:79]
  ds_read_b128 v[28:31], v2 offset:27648
  v_mul_f32 v81, v81, v97
  v_mul_f32 v82, v82, v98
  v_mul_f32 v83, v83, v99
  v_mul_f32 v84, v84, v100
  s_waitcnt lgkmcnt(11)
  v_mfma_f32_32x32x16_bf16 v[64:79], v[32:35], v[176:179], v[64:79]
  ds_read_b128 v[32:35], v2 offset:28672
  buffer_load_dwordx4 v3, s[12:15], s62 offen offset:3072 sc1 lds
  v_mul_f32 v85, v85, v101
  v_mul_f32 v86, v86, v102
  v_mul_f32 v87, v87, v103
  v_cvt_pk_bf16_f32 v104, v80, v81
  s_waitcnt lgkmcnt(11)
  v_mfma_f32_32x32x16_bf16 v[64:79], v[36:39], v[180:183], v[64:79]
  ds_read_b128 v[36:39], v2 offset:29696
  v_cvt_pk_bf16_f32 v105, v82, v83
  v_cvt_pk_bf16_f32 v106, v84, v85
  v_cvt_pk_bf16_f32 v107, v86, v87
  s_waitcnt lgkmcnt(11)
  v_mfma_f32_32x32x16_bf16 v[64:79], v[40:43], v[184:187], v[64:79]
  ds_read_b128 v[40:43], v2 offset:30720
  v_mul_f32 v96, v88, v88
  v_mul_f32 v97, v89, v89
  v_mul_f32 v98, v90, v90
  v_mul_f32 v99, v91, v91
  s_waitcnt lgkmcnt(11)
  v_mfma_f32_32x32x16_bf16 v[64:79], v[44:47], v[188:191], v[64:79]
  ds_read_b128 v[44:47], v2 offset:31744
  v_mul_f32 v100, v92, v92
  v_mul_f32 v101, v93, v93
  v_mul_f32 v102, v94, v94
  v_mul_f32 v103, v95, v95
  s_waitcnt lgkmcnt(11)
  v_mfma_f32_32x32x16_bf16 v[64:79], v[48:51], v[192:195], v[64:79]
  ds_read_b128 v[48:51], v2 offset:32768
  s_add_u32 m0, s60, 8192
  s_add_u32 s62, s40, 8192
  buffer_load_dwordx4 v3, s[12:15], s62 offen offset:0 sc1 lds
  v_fma_f32 v96, v96, s54, v5
  v_fma_f32 v97, v97, s54, v5
  v_fma_f32 v98, v98, s54, v5
  v_fma_f32 v99, v99, s54, v5
  s_waitcnt lgkmcnt(11)
  v_mfma_f32_32x32x16_bf16 v[64:79], v[52:55], v[196:199], v[64:79]
  ds_read_b128 v[52:55], v2 offset:33792
  v_fma_f32 v100, v100, s54, v5
  v_fma_f32 v101, v101, s54, v5
  v_fma_f32 v102, v102, s54, v5
  s_waitcnt lgkmcnt(11)
  v_mfma_f32_32x32x16_bf16 v[64:79], v[56:59], v[200:203], v[64:79]
  ds_read_b128 v[56:59], v2 offset:34816
  v_fma_f32 v103, v103, s54, v5
  v_mul_f32 v96, v96, v88
  v_mul_f32 v97, v97, v89
  v_mul_f32 v98, v98, v90
  s_waitcnt lgkmcnt(11)
  v_mfma_f32_32x32x16_bf16 v[64:79], v[60:63], v[204:207], v[64:79]
  ds_read_b128 v[60:63], v2 offset:35840
  v_mul_f32 v99, v99, v91
  v_mul_f32 v100, v100, v92
  v_mul_f32 v101, v101, v93
  v_mul_f32 v102, v102, v94
  s_waitcnt lgkmcnt(11)
  v_mfma_f32_32x32x16_bf16 v[64:79], v[16:19], v[208:211], v[64:79]
  s_waitcnt vmcnt(9)
  s_barrier
  s_add_u32 s42, s42, 1
  s_and_b32 s53, s42, 3
  s_cmp_eq_u32 s53, 0
  s_cselect_b32 s53, 4294856704, s63
  v_add_u32 v2, s53, v2
  s_add_u32 s40, s40, 36864
  s_add_u32 s39, s39, 36864
  s_cmp_eq_u32 s39, 147456
  s_cselect_b32 s39, 0, s39
  s_cmp_eq_u32 s42, 7
  s_cselect_b32 s12, s66, s12
  s_cselect_b32 s13, s67, s13
  s_cselect_b32 s14, 746496, s14
  s_cselect_b32 s40, s65, s40
  s_add_u32 s60, s58, s39
  ds_read_b128 v[16:19], v2 offset:0
  s_add_u32 m0, s60, 0
  s_add_u32 s62, s40, 0
  buffer_load_dwordx4 v3, s[12:15], s62 offen offset:0 sc1 lds
  v_mul_f32 v103, v103, v95
  v_exp_f32 v96, v96
  v_exp_f32 v97, v97
  v_exp_f32 v98, v98
  s_waitcnt lgkmcnt(11)
  v_mfma_f32_32x32x16_bf16 v[64:79], v[20:23], v[212:215], v[64:79]
  ds_read_b128 v[20:23], v2 offset:1024
  v_exp_f32 v99, v99
  v_exp_f32 v100, v100
  v_exp_f32 v101, v101
  s_waitcnt lgkmcnt(11)
  v_mfma_f32_32x32x16_bf16 v[64:79], v[24:27], v[216:219], v[64:79]
  ds_read_b128 v[24:27], v2 offset:2048
  v_exp_f32 v102, v102
  v_exp_f32 v103, v103
  v_add_f32 v96, 1.0, v96
  v_add_f32 v97, 1.0, v97
  s_waitcnt lgkmcnt(11)
  v_mfma_f32_32x32x16_bf16 v[64:79], v[28:31], v[220:223], v[64:79]
  ds_read_b128 v[28:31], v2 offset:3072
  v_add_f32 v98, 1.0, v98
  v_add_f32 v99, 1.0, v99
  v_add_f32 v100, 1.0, v100
  v_add_f32 v101, 1.0, v101
  s_waitcnt lgkmcnt(11)
  v_mfma_f32_32x32x16_bf16 v[64:79], v[32:35], v[224:227], v[64:79]
  ds_read_b128 v[32:35], v2 offset:4096
  buffer_load_dwordx4 v3, s[12:15], s62 offen offset:1024 sc1 lds
  v_add_f32 v102, 1.0, v102
  v_add_f32 v103, 1.0, v103
  v_rcp_f32 v96, v96
  v_rcp_f32 v97, v97
  s_waitcnt lgkmcnt(11)
  v_mfma_f32_32x32x16_bf16 v[64:79], v[36:39], v[228:231], v[64:79]
  ds_read_b128 v[36:39], v2 offset:5120
  v_rcp_f32 v98, v98
  v_rcp_f32 v99, v99
  v_rcp_f32 v100, v100
  s_waitcnt lgkmcnt(11)
  v_mfma_f32_32x32x16_bf16 v[64:79], v[40:43], v[232:235], v[64:79]
  ds_read_b128 v[40:43], v2 offset:6144
  v_rcp_f32 v101, v101
  v_rcp_f32 v102, v102
  v_rcp_f32 v103, v103
  v_mul_f32 v88, v88, v96
  s_waitcnt lgkmcnt(11)
  v_mfma_f32_32x32x16_bf16 v[64:79], v[44:47], v[236:239], v[64:79]
  ds_read_b128 v[44:47], v2 offset:7168
  v_mul_f32 v89, v89, v97
  v_mul_f32 v90, v90, v98
  v_mul_f32 v91, v91, v99
  v_mul_f32 v92, v92, v100
  s_waitcnt lgkmcnt(11)
  v_mfma_f32_32x32x16_bf16 v[64:79], v[48:51], v[240:243], v[64:79]
  ds_read_b128 v[48:51], v2 offset:8192
  buffer_load_dwordx4 v3, s[12:15], s62 offen offset:2048 sc1 lds
  v_mul_f32 v93, v93, v101
  v_mul_f32 v94, v94, v102
  v_mul_f32 v95, v95, v103
  v_cvt_pk_bf16_f32 v108, v88, v89
  s_waitcnt lgkmcnt(11)
  v_mfma_f32_32x32x16_bf16 v[64:79], v[52:55], v[244:247], v[64:79]
  ds_read_b128 v[52:55], v2 offset:9216
  v_cvt_pk_bf16_f32 v109, v90, v91
  v_cvt_pk_bf16_f32 v110, v92, v93
  v_cvt_pk_bf16_f32 v111, v94, v95
  s_waitcnt lgkmcnt(11)
  v_mfma_f32_32x32x16_bf16 v[64:79], v[56:59], v[248:251], v[64:79]
  ds_read_b128 v[56:59], v2 offset:10240
  buffer_store_dwordx4 v[104:107], v4, s[16:19], s41 offen offset:0 sc1
  buffer_store_dwordx4 v[108:111], v4, s[16:19], s41 offen offset:512 sc1
  s_add_u32 s41, s41, 1024
  s_waitcnt lgkmcnt(11)
  v_mfma_f32_32x32x16_bf16 v[64:79], v[60:63], v[252:255], v[64:79]
  ds_read_b128 v[60:63], v2 offset:11264
  s_cmp_lt_u32 s42, 9
  s_cbranch_scc1 K3_LOOP
  s_and_b32 s56, s50, 3
  s_lshl_b32 s56, s56, 3
  s_and_b32 s57, s51, 7
  s_add_u32 s56, s56, s57
  s_lshr_b32 s57, s56, 1
  s_lshl_b32 s57, s57, 7
  s_add_u32 s68, s57, 2048
  s_lshl_b32 s56, s56, 7
  s_add_u32 s69, s56, 4096
  s_cmp_eq_u32 s36, 0
  s_cbranch_scc0 K3_NF
  s_mov_b64 exec, 1
  buffer_load_dword v14, v9, s[24:27], s68 offen sc1
  buffer_load_dword v15, v9, s[24:27], s69 offen sc1
  s_mov_b64 exec, -1
K3_NF:
  v_mov_b32 v12, s54
  v_mov_b32 v13, v5
  s_waitcnt lgkmcnt(0)
  v_pk_mul_f32 v[16:17], v[64:65], v[64:65]
  v_pk_mul_f32 v[18:19], v[66:67], v[66:67]
  v_pk_mul_f32 v[20:21], v[68:69], v[68:69]
  v_pk_mul_f32 v[22:23], v[70:71], v[70:71]
  v_pk_mul_f32 v[24:25], v[72:73], v[72:73]
  v_pk_mul_f32 v[26:27], v[74:75], v[74:75]
  v_pk_mul_f32 v[28:29], v[76:77], v[76:77]
  v_pk_mul_f32 v[30:31], v[78:79], v[78:79]
  v_pk_fma_f32 v[16:17], v[16:17], v[12:13], v[12:13] op_sel:[0,0,1] op_sel_hi:[1,0,1]
  v_pk_fma_f32 v[18:19], v[18:19], v[12:13], v[12:13] op_sel:[0,0,1] op_sel_hi:[1,0,1]
  v_pk_fma_f32 v[20:21], v[20:21], v[12:13], v[12:13] op_sel:[0,0,1] op_sel_hi:[1,0,1]
  v_pk_fma_f32 v[22:23], v[22:23], v[12:13], v[12:13] op_sel:[0,0,1] op_sel_hi:[1,0,1]
  v_pk_fma_f32 v[24:25], v[24:25], v[12:13], v[12:13] op_sel:[0,0,1] op_sel_hi:[1,0,1]
  v_pk_fma_f32 v[26:27], v[26:27], v[12:13], v[12:13] op_sel:[0,0,1] op_sel_hi:[1,0,1]
  v_pk_fma_f32 v[28:29], v[28:29], v[12:13], v[12:13] op_sel:[0,0,1] op_sel_hi:[1,0,1]
  v_pk_fma_f32 v[30:31], v[30:31], v[12:13], v[12:13] op_sel:[0,0,1] op_sel_hi:[1,0,1]
  v_pk_mul_f32 v[16:17], v[16:17], v[64:65]
  v_pk_mul_f32 v[18:19], v[18:19], v[66:67]
  v_pk_mul_f32 v[20:21], v[20:21], v[68:69]
  v_pk_mul_f32 v[22:23], v[22:23], v[70:71]
  v_pk_mul_f32 v[24:25], v[24:25], v[72:73]
  v_pk_mul_f32 v[26:27], v[26:27], v[74:75]
  v_pk_mul_f32 v[28:29], v[28:29], v[76:77]
  v_pk_mul_f32 v[30:31], v[30:31], v[78:79]
  v_exp_f32 v16, v16
  v_exp_f32 v17, v17
  v_exp_f32 v18, v18
  v_exp_f32 v19, v19
  v_exp_f32 v20, v20
  v_exp_f32 v21, v21
  v_exp_f32 v22, v22
  v_exp_f32 v23, v23
  v_exp_f32 v24, v24
  v_exp_f32 v25, v25
  v_exp_f32 v26, v26
  v_exp_f32 v27, v27
  v_exp_f32 v28, v28
  v_exp_f32 v29, v29
  v_exp_f32 v30, v30
  v_exp_f32 v31, v31
  v_pk_add_f32 v[16:17], v[16:17], 1.0 op_sel_hi:[1,0]
  v_pk_add_f32 v[18:19], v[18:19], 1.0 op_sel_hi:[1,0]
  v_pk_add_f32 v[20:21], v[20:21], 1.0 op_sel_hi:[1,0]
  v_pk_add_f32 v[22:23], v[22:23], 1.0 op_sel_hi:[1,0]
  v_pk_add_f32 v[24:25], v[24:25], 1.0 op_sel_hi:[1,0]
  v_pk_add_f32 v[26:27], v[26:27], 1.0 op_sel_hi:[1,0]
  v_pk_add_f32 v[28:29], v[28:29], 1.0 op_sel_hi:[1,0]
  v_pk_add_f32 v[30:31], v[30:31], 1.0 op_sel_hi:[1,0]
  v_rcp_f32 v16, v16
  v_rcp_f32 v17, v17
  v_rcp_f32 v18, v18
  v_rcp_f32 v19, v19
  v_rcp_f32 v20, v20
  v_rcp_f32 v21, v21
  v_rcp_f32 v22, v22
  v_rcp_f32 v23, v23
  v_rcp_f32 v24, v24
  v_rcp_f32 v25, v25
  v_rcp_f32 v26, v26
  v_rcp_f32 v27, v27
  v_rcp_f32 v28, v28
  v_rcp_f32 v29, v29
  v_rcp_f32 v30, v30
  v_rcp_f32 v31, v31
  v_pk_mul_f32 v[64:65], v[64:65], v[16:17]
  v_pk_mul_f32 v[66:67], v[66:67], v[18:19]
  v_pk_mul_f32 v[68:69], v[68:69], v[20:21]
  v_pk_mul_f32 v[70:71], v[70:71], v[22:23]
  v_pk_mul_f32 v[72:73], v[72:73], v[24:25]
  v_pk_mul_f32 v[74:75], v[74:75], v[26:27]
  v_pk_mul_f32 v[76:77], v[76:77], v[28:29]
  v_pk_mul_f32 v[78:79], v[78:79], v[30:31]
  v_cvt_pk_bf16_f32 v104, v64, v65
  v_cvt_pk_bf16_f32 v105, v66, v67
  v_cvt_pk_bf16_f32 v106, v68, v69
  v_cvt_pk_bf16_f32 v107, v70, v71
  v_cvt_pk_bf16_f32 v108, v72, v73
  v_cvt_pk_bf16_f32 v109, v74, v75
  v_cvt_pk_bf16_f32 v110, v76, v77
  v_cvt_pk_bf16_f32 v111, v78, v79
  buffer_store_dwordx4 v[104:107], v4, s[16:19], s41 offen offset:0 sc1
  buffer_store_dwordx4 v[108:111], v4, s[16:19], s41 offen offset:512 sc1
  s_add_u32 s41, s41, 1024
  s_and_b32 s52, s50, 3
  s_lshl_b32 s52, s52, 3
  s_and_b32 s53, s51, 7
  s_add_u32 s37, s52, s53
  s_lshr_b32 s52, s50, 2
  s_lshl_b32 s52, s52, 2
  s_lshr_b32 s53, s51, 3
  s_add_u32 s38, s52, s53
  v_lshlrev_b32 v4, 4, v1
  v_add_u32 v2, 36864, v4
  v_lshrrev_b32 v8, 4, v1
  v_and_b32 v9, 7, v1
  v_lshlrev_b32 v9, 4, v9
  v_lshl_add_u32 v3, v8, 7, v9
  v_add_u32 v3, 40960, v3
  s_mul_i32 s52, s38, 746496
  s_lshl_b32 s53, s37, 2
  s_add_u32 s53, s53, s36
  s_mul_i32 s55, s53, 165888
  s_mov_b32 s41, 0
  v_add_u32 v8, 0, v1
  v_mul_u32_u24 v9, 7282, v8
  v_lshrrev_b32 v9, 16, v9
  v_mul_u32_u24 v10, 9, v9
  v_sub_u32 v10, v8, v10
  v_lshlrev_b32 v10, 4, v10
  v_mul_u32_u24 v11, 160, v9
  v_add_u32 v16, v10, v11
  v_mul_u32_u24 v9, 1152, v9
  v_add_u32 v5, v9, v10
  v_add_u32 v8, 64, v1
  v_mul_u32_u24 v9, 7282, v8
  v_lshrrev_b32 v9, 16, v9
  v_mul_u32_u24 v10, 9, v9
  v_sub_u32 v10, v8, v10
  v_lshlrev_b32 v10, 4, v10
  v_mul_u32_u24 v11, 160, v9
  v_add_u32 v17, v10, v11
  v_mul_u32_u24 v9, 1152, v9
  v_add_u32 v6, v9, v10
  v_add_u32 v8, 128, v1
  v_mul_u32_u24 v9, 7282, v8
  v_lshrrev_b32 v9, 16, v9
  v_mul_u32_u24 v10, 9, v9
  v_sub_u32 v10, v8, v10
  v_lshlrev_b32 v10, 4, v10
  v_mul_u32_u24 v11, 160, v9
  v_add_u32 v18, v10, v11
  v_mul_u32_u24 v9, 1152, v9
  v_add_u32 v7, v9, v10
  v_cmp_gt_u32 vcc, 16, v1
  v_mov_b32 v8, 1073741824
  s_nop 0
  v_cndmask_b32 v7, v8, v7, vcc
  v_cndmask_b32 v18, 0, v18, vcc
  s_waitcnt lgkmcnt(0)
  s_add_u32 s8, s4, s55
  s_addc_u32 s9, s5, 0
  s_add_u32 s8, s8, 33554432
  s_addc_u32 s9, s9, 0
  s_mov_b32 s10, 165888
  s_mov_b32 s11, 0x20000
  s_mov_b32 s16, s6
  s_mov_b32 s17, s7
  s_mov_b32 s18, 2359296
  s_mov_b32 s19, 0x20000
  s_add_u32 s20, s4, 12582912
  s_addc_u32 s21, s5, 0
  s_mov_b32 s22, 2359296
  s_mov_b32 s23, 0x20000
  s_mul_i32 s56, s53, 18432
  s_mul_i32 s57, s38, 144
  s_add_u32 s56, s56, s57
  s_mul_i32 s57, s53, 18432
  s_mul_i32 s59, s38, 2304
  s_add_u32 s57, s57, s59
  v_lshlrev_b32 v8, 3, v1
  v_mov_b32 v128, 0
  v_mov_b32 v129, 0
  v_mov_b32 v130, 0
  v_mov_b32 v131, 0
  v_mov_b32 v132, 0
  v_mov_b32 v133, 0
  v_mov_b32 v134, 0
  v_mov_b32 v135, 0
  v_mov_b32 v136, 0
  v_mov_b32 v137, 0
  v_mov_b32 v138, 0
  v_mov_b32 v139, 0
  v_mov_b32 v140, 0
  v_mov_b32 v141, 0
  v_mov_b32 v142, 0
  v_mov_b32 v143, 0
  v_mov_b32 v144, 0
  v_mov_b32 v145, 0
  v_mov_b32 v146, 0
  v_mov_b32 v147, 0
  s_mov_b32 s42, 0
  s_mov_b32 s63, 36864
  s_lshr_b32 s65, s37, 1
  s_lshl_b32 s65, s65, 7
  v_mov_b32 v9, 0
  v_mov_b32 v10, 1
  s_mov_b32 s66, 0
  s_waitcnt vmcnt(0)
  s_cmp_eq_u32 s36, 0
  s_cbranch_scc0 K4_P1
K4_P0:
  v_readfirstlane_b32 s61, v14
  v_readfirstlane_b32 s67, v15
  s_add_u32 s66, s66, 1
  s_min_u32 s61, s61, s67
  s_cmp_ge_u32 s61, 32
  s_cbranch_scc1 K4_P1
  s_cmp_ge_u32 s66, 0x20000
  s_cbranch_scc1 K4_P1
  s_sleep 4
  s_mov_b64 exec, 1
  buffer_load_dword v14, v9, s[24:27], s68 offen sc1
  buffer_load_dword v15, v9, s[24:27], s69 offen sc1
  s_mov_b64 exec, -1
  s_waitcnt vmcnt(0)
  s_branch K4_P0
K4_P1:
  s_mov_b32 s66, 0
  s_barrier
  s_cmp_eq_u32 s36, 0
  s_cbranch_scc0 K4_NOSIG
  s_mov_b64 exec, 1
  buffer_atomic_add v10, v9, s[24:27], s64 offen sc1
  s_mov_b64 exec, -1
K4_NOSIG:
  buffer_load_dwordx4 v[64:67], v4, s[8:11], s41 offen offset:0 sc1
  buffer_load_dwordx4 v[68:71], v4, s[8:11], s41 offen offset:1024 sc1
  buffer_load_dwordx4 v[72:75], v4, s[8:11], s41 offen offset:2048 sc1
  buffer_load_dwordx4 v[76:79], v4, s[8:11], s41 offen offset:3072 sc1
  s_add_u32 s41, s41, 4096
  buffer_load_dwordx4 v[80:83], v4, s[8:11], s41 offen offset:0 sc1
  buffer_load_dwordx4 v[84:87], v4, s[8:11], s41 offen offset:1024 sc1
  buffer_load_dwordx4 v[88:91], v4, s[8:11], s41 offen offset:2048 sc1
  buffer_load_dwordx4 v[92:95], v4, s[8:11], s41 offen offset:3072 sc1
  s_add_u32 s41, s41, 4096
  buffer_load_dwordx4 v[96:99], v4, s[8:11], s41 offen offset:0 sc1
  buffer_load_dwordx4 v[100:103], v4, s[8:11], s41 offen offset:1024 sc1
  buffer_load_dwordx4 v[104:107], v4, s[8:11], s41 offen offset:2048 sc1
  buffer_load_dwordx4 v[108:111], v4, s[8:11], s41 offen offset:3072 sc1
  s_add_u32 s41, s41, 4096
  buffer_load_dwordx4 v[112:115], v4, s[8:11], s41 offen offset:0 sc1
  buffer_load_dwordx4 v[116:119], v4, s[8:11], s41 offen offset:1024 sc1
  buffer_load_dwordx4 v[120:123], v4, s[8:11], s41 offen offset:2048 sc1
  buffer_load_dwordx4 v[124:127], v4, s[8:11], s41 offen offset:3072 sc1
  s_add_u32 s41, s41, 4096
  ds_read_b128 v[24:27], v2 offset:0
  ds_read_b128 v[28:31], v2 offset:1024
  ds_read_b128 v[32:35], v2 offset:2048
  ds_read_b128 v[36:39], v2 offset:3072
  ds_read_b128 v[40:43], v3 offset:0
  ds_read_b128 v[44:47], v2 offset:4608
  ds_read_b128 v[48:51], v2 offset:5632
  ds_read_b128 v[52:55], v2 offset:6656
  ds_read_b128 v[56:59], v2 offset:7680
  ds_read_b128 v[60:63], v3 offset:4608
  buffer_load_dwordx4 v4, s[12:15], s62 offen offset:2048 sc1 lds
  s_waitcnt vmcnt(16)
  s_waitcnt lgkmcnt(5)
  v_mfma_f32_16x16x32_bf16 v[128:131], v[24:27], v[64:67], v[128:131]
  v_mfma_f32_16x16x32_bf16 v[132:135], v[28:31], v[64:67], v[132:135]
  v_mfma_f32_16x16x32_bf16 v[136:139], v[32:35], v[64:67], v[136:139]
  v_mfma_f32_16x16x32_bf16 v[140:143], v[36:39], v[64:67], v[140:143]
  v_mfma_f32_16x16x32_bf16 v[144:147], v[40:43], v[64:67], v[144:147]
  buffer_load_dwordx4 v[64:67], v4, s[8:11], s41 offen offset:0 sc1
  ds_read_b128 v[24:27], v2 offset:9216
  ds_read_b128 v[28:31], v2 offset:10240
  ds_read_b128 v[32:35], v2 offset:11264
  ds_read_b128 v[36:39], v2 offset:12288
  ds_read_b128 v[40:43], v3 offset:9216
  buffer_load_dwordx4 v4, s[12:15], s62 offen offset:3072 sc1 lds
  s_waitcnt vmcnt(17)
  s_waitcnt lgkmcnt(5)
  v_mfma_f32_16x16x32_bf16 v[128:131], v[44:47], v[68:71], v[128:131]
  v_mfma_f32_16x16x32_bf16 v[132:135], v[48:51], v[68:71], v[132:135]
  v_mfma_f32_16x16x32_bf16 v[136:139], v[52:55], v[68:71], v[136:139]
  v_mfma_f32_16x16x32_bf16 v[140:143], v[56:59], v[68:71], v[140:143]
  v_mfma_f32_16x16x32_bf16 v[144:147], v[60:63], v[68:71], v[144:147]
  buffer_load_dwordx4 v[68:71], v4, s[8:11], s41 offen offset:1024 sc1
  ds_read_b128 v[44:47], v2 offset:13824
  ds_read_b128 v[48:51], v2 offset:14848
  ds_read_b128 v[52:55], v2 offset:15872
  ds_read_b128 v[56:59], v2 offset:16896
  ds_read_b128 v[60:63], v3 offset:13824
  s_add_u32 m0, s60, 4096
  s_add_u32 s62, s40, 4096
  buffer_load_dwordx4 v4, s[12:15], s62 offen offset:0 sc1 lds
  s_waitcnt vmcnt(18)
  s_waitcnt lgkmcnt(5)
  v_mfma_f32_16x16x32_bf16 v[128:131], v[24:27], v[72:75], v[128:131]
  v_mfma_f32_16x16x32_bf16 v[132:135], v[28:31], v[72:75], v[132:135]
  v_mfma_f32_16x16x32_bf16 v[136:139], v[32:35], v[72:75], v[136:139]
  v_mfma_f32_16x16x32_bf16 v[140:143], v[36:39], v[72:75], v[140:143]
  v_mfma_f32_16x16x32_bf16 v[144:147], v[40:43], v[72:75], v[144:147]
  buffer_load_dwordx4 v[168:171], v5, s[16:19], s56 offen
  buffer_load_dwordx4 v[172:175], v6, s[16:19], s56 offen
  buffer_load_dwordx4 v[176:179], v7, s[16:19], s56 offen
  buffer_load_dwordx2 v[180:181], v8, s[20:23], s57 offen offset:0 sc1
  buffer_load_dwordx2 v[182:183], v8, s[20:23], s57 offen offset:512 sc1
  buffer_load_dwordx2 v[184:185], v8, s[20:23], s57 offen offset:1024 sc1
  buffer_load_dwordx2 v[186:187], v8, s[20:23], s57 offen offset:1536 sc1
  buffer_load_dwordx2 v[188:189], v8, s[20:23], s57 offen offset:2048 sc1
  ds_read_b128 v[24:27], v2 offset:18432
  ds_read_b128 v[28:31], v2 offset:19456
  ds_read_b128 v[32:35], v2 offset:20480
  ds_read_b128 v[36:39], v2 offset:21504
  ds_read_b128 v[40:43], v3 offset:18432
  buffer_load_dwordx4 v4, s[12:15], s62 offen offset:1024 sc1 lds
  s_waitcnt vmcnt(26)
  s_waitcnt lgkmcnt(5)
  v_mfma_f32_16x16x32_bf16 v[128:131], v[44:47], v[76:79], v[128:131]
  v_mfma_f32_16x16x32_bf16 v[132:135], v[48:51], v[76:79], v[132:135]
  v_mfma_f32_16x16x32_bf16 v[136:139], v[52:55], v[76:79], v[136:139]
  v_mfma_f32_16x16x32_bf16 v[140:143], v[56:59], v[76:79], v[140:143]
  v_mfma_f32_16x16x32_bf16 v[144:147], v[60:63], v[76:79], v[144:147]
  ds_read_b128 v[44:47], v2 offset:23040
  ds_read_b128 v[48:51], v2 offset:24064
  ds_read_b128 v[52:55], v2 offset:25088
  ds_read_b128 v[56:59], v2 offset:26112
  ds_read_b128 v[60:63], v3 offset:23040
  buffer_load_dwordx4 v4, s[12:15], s62 offen offset:2048 sc1 lds
  s_waitcnt vmcnt(26)
  s_waitcnt lgkmcnt(5)
  v_mfma_f32_16x16x32_bf16 v[128:131], v[24:27], v[80:83], v[128:131]
  v_mfma_f32_16x16x32_bf16 v[132:135], v[28:31], v[80:83], v[132:135]
  v_mfma_f32_16x16x32_bf16 v[136:139], v[32:35], v[80:83], v[136:139]
  v_mfma_f32_16x16x32_bf16 v[140:143], v[36:39], v[80:83], v[140:143]
  v_mfma_f32_16x16x32_bf16 v[144:147], v[40:43], v[80:83], v[144:147]
  ds_read_b128 v[24:27], v2 offset:27648
  ds_read_b128 v[28:31], v2 offset:28672
  ds_read_b128 v[32:35], v2 offset:29696
  ds_read_b128 v[36:39], v2 offset:30720
  ds_read_b128 v[40:43], v3 offset:27648
  buffer_load_dwordx4 v4, s[12:15], s62 offen offset:3072 sc1 lds
  s_waitcnt vmcnt(26)
  s_waitcnt lgkmcnt(5)
  v_mfma_f32_16x16x32_bf16 v[128:131], v[44:47], v[84:87], v[128:131]
  v_mfma_f32_16x16x32_bf16 v[132:135], v[48:51], v[84:87], v[132:135]
  v_mfma_f32_16x16x32_bf16 v[136:139], v[52:55], v[84:87], v[136:139]
  v_mfma_f32_16x16x32_bf16 v[140:143], v[56:59], v[84:87], v[140:143]
  v_mfma_f32_16x16x32_bf16 v[144:147], v[60:63], v[84:87], v[144:147]
  ds_read_b128 v[44:47], v2 offset:32256
  ds_read_b128 v[48:51], v2 offset:33280
  ds_read_b128 v[52:55], v2 offset:34304
  ds_read_b128 v[56:59], v2 offset:35328
  ds_read_b128 v[60:63], v3 offset:32256
  s_add_u32 m0, s60, 8192
  s_add_u32 s62, s40, 8192
  buffer_load_dwordx4 v4, s[12:15], s62 offen offset:0 sc1 lds
  s_waitcnt vmcnt(26)
  s_waitcnt lgkmcnt(5)
  v_mfma_f32_16x16x32_bf16 v[128:131], v[24:27], v[88:91], v[128:131]
  v_mfma_f32_16x16x32_bf16 v[132:135], v[28:31], v[88:91], v[132:135]
  v_mfma_f32_16x16x32_bf16 v[136:139], v[32:35], v[88:91], v[136:139]
  v_mfma_f32_16x16x32_bf16 v[140:143], v[36:39], v[88:91], v[140:143]
  v_mfma_f32_16x16x32_bf16 v[144:147], v[40:43], v[88:91], v[144:147]
  s_add_u32 s42, s42, 1
  s_and_b32 s52, s42, 3
  s_cmp_eq_u32 s52, 3
  s_cselect_b32 s52, 4294856704, s63
  v_add_u32 v2, s52, v2
  v_add_u32 v3, s52, v3
  s_add_u32 s40, s40, 36864
  s_add_u32 s39, s39, 36864
  s_cmp_eq_u32 s39, 147456
  s_cselect_b32 s39, 0, s39
  s_add_u32 s60, s58, s39
  ds_read_b128 v[24:27], v2 offset:0
  ds_read_b128 v[28:31], v2 offset:1024
  ds_read_b128 v[32:35], v2 offset:2048
  ds_read_b128 v[36:39], v2 offset:3072
  ds_read_b128 v[40:43], v3 offset:0
  s_add_u32 m0, s60, 0
  s_add_u32 s62, s40, 0
  buffer_load_dwordx4 v4, s[12:15], s62 offen offset:0 sc1 lds
  buffer_load_dwordx4 v4, s[12:15], s62 offen offset:1024 sc1 lds
  s_waitcnt vmcnt(27)
  s_waitcnt lgkmcnt(5)
  v_mfma_f32_16x16x32_bf16 v[128:131], v[44:47], v[92:95], v[128:131]
  v_mfma_f32_16x16x32_bf16 v[132:135], v[48:51], v[92:95], v[132:135]
  v_mfma_f32_16x16x32_bf16 v[136:139], v[52:55], v[92:95], v[136:139]
  v_mfma_f32_16x16x32_bf16 v[140:143], v[56:59], v[92:95], v[140:143]
  v_mfma_f32_16x16x32_bf16 v[144:147], v[60:63], v[92:95], v[144:147]
  ds_read_b128 v[44:47], v2 offset:4608
  ds_read_b128 v[48:51], v2 offset:5632
  ds_read_b128 v[52:55], v2 offset:6656
  ds_read_b128 v[56:59], v2 offset:7680
  ds_read_b128 v[60:63], v3 offset:4608
  buffer_load_dwordx4 v4, s[12:15], s62 offen offset:2048 sc1 lds
  s_waitcnt vmcnt(27)
  s_waitcnt lgkmcnt(5)
  v_mfma_f32_16x16x32_bf16 v[128:131], v[24:27], v[96:99], v[128:131]
  v_mfma_f32_16x16x32_bf16 v[132:135], v[28:31], v[96:99], v[132:135]
  v_mfma_f32_16x16x32_bf16 v[136:139], v[32:35], v[96:99], v[136:139]
  v_mfma_f32_16x16x32_bf16 v[140:143], v[36:39], v[96:99], v[140:143]
  v_mfma_f32_16x16x32_bf16 v[144:147], v[40:43], v[96:99], v[144:147]
  ds_read_b128 v[24:27], v2 offset:9216
  ds_read_b128 v[28:31], v2 offset:10240
  ds_read_b128 v[32:35], v2 offset:11264
  ds_read_b128 v[36:39], v2 offset:12288
  ds_read_b128 v[40:43], v3 offset:9216
  buffer_load_dwordx4 v4, s[12:15], s62 offen offset:3072 sc1 lds
  s_waitcnt vmcnt(27)
  s_waitcnt lgkmcnt(5)
  v_mfma_f32_16x16x32_bf16 v[128:131], v[44:47], v[100:103], v[128:131]
  v_mfma_f32_16x16x32_bf16 v[132:135], v[48:51], v[100:103], v[132:135]
  v_mfma_f32_16x16x32_bf16 v[136:139], v[52:55], v[100:103], v[136:139]
  v_mfma_f32_16x16x32_bf16 v[140:143], v[56:59], v[100:103], v[140:143]
  v_mfma_f32_16x16x32_bf16 v[144:147], v[60:63], v[100:103], v[144:147]
  ds_read_b128 v[44:47], v2 offset:13824
  ds_read_b128 v[48:51], v2 offset:14848
  ds_read_b128 v[52:55], v2 offset:15872
  ds_read_b128 v[56:59], v2 offset:16896
  ds_read_b128 v[60:63], v3 offset:13824
  s_add_u32 m0, s60, 4096
  s_add_u32 s62, s40, 4096
  buffer_load_dwordx4 v4, s[12:15], s62 offen offset:0 sc1 lds
  s_waitcnt vmcnt(27)
  s_waitcnt lgkmcnt(5)
  v_mfma_f32_16x16x32_bf16 v[128:131], v[24:27], v[104:107], v[128:131]
  v_mfma_f32_16x16x32_bf16 v[132:135], v[28:31], v[104:107], v[132:135]
  v_mfma_f32_16x16x32_bf16 v[136:139], v[32:35], v[104:107], v[136:139]
  v_mfma_f32_16x16x32_bf16 v[140:143], v[36:39], v[104:107], v[140:143]
  v_mfma_f32_16x16x32_bf16 v[144:147], v[40:43], v[104:107], v[144:147]
  s_cmp_eq_u32 s36, 0
  s_cselect_b32 s67, s65, 1073741824
  s_mov_b64 exec, 1
  buffer_load_dword v11, v9, s[24:27], s67 offen sc1
  s_mov_b64 exec, -1
  ds_read_b128 v[24:27], v2 offset:18432
  ds_read_b128 v[28:31], v2 offset:19456
  ds_read_b128 v[32:35], v2 offset:20480
  ds_read_b128 v[36:39], v2 offset:21504
  ds_read_b128 v[40:43], v3 offset:18432
  buffer_load_dwordx4 v4, s[12:15], s62 offen offset:1024 sc1 lds
  s_waitcnt vmcnt(28)
  s_waitcnt lgkmcnt(5)
  v_mfma_f32_16x16x32_bf16 v[128:131], v[44:47], v[108:111], v[128:131]
  v_mfma_f32_16x16x32_bf16 v[132:135], v[48:51], v[108:111], v[132:135]
  v_mfma_f32_16x16x32_bf16 v[136:139], v[52:55], v[108:111], v[136:139]
  v_mfma_f32_16x16x32_bf16 v[140:143], v[56:59], v[108:111], v[140:143]
  v_mfma_f32_16x16x32_bf16 v[144:147], v[60:63], v[108:111], v[144:147]
  ds_read_b128 v[44:47], v2 offset:23040
  ds_read_b128 v[48:51], v2 offset:24064
  ds_read_b128 v[52:55], v2 offset:25088
  ds_read_b128 v[56:59], v2 offset:26112
  ds_read_b128 v[60:63], v3 offset:23040
  buffer_load_dwordx4 v4, s[12:15], s62 offen offset:2048 sc1 lds
  s_waitcnt vmcnt(28)
  s_waitcnt lgkmcnt(5)
  v_mfma_f32_16x16x32_bf16 v[128:131], v[24:27], v[112:115], v[128:131]
  v_mfma_f32_16x16x32_bf16 v[132:135], v[28:31], v[112:115], v[132:135]
  v_mfma_f32_16x16x32_bf16 v[136:139], v[32:35], v[112:115], v[136:139]
  v_mfma_f32_16x16x32_bf16 v[140:143], v[36:39], v[112:115], v[140:143]
  v_mfma_f32_16x16x32_bf16 v[144:147], v[40:43], v[112:115], v[144:147]
  ds_read_b128 v[24:27], v2 offset:27648
  ds_read_b128 v[28:31], v2 offset:28672
  ds_read_b128 v[32:35], v2 offset:29696
  ds_read_b128 v[36:39], v2 offset:30720
  ds_read_b128 v[40:43], v3 offset:27648
  buffer_load_dwordx4 v4, s[12:15], s62 offen offset:3072 sc1 lds
  s_waitcnt vmcnt(28)
  s_waitcnt lgkmcnt(5)
  v_mfma_f32_16x16x32_bf16 v[128:131], v[44:47], v[116:119], v[128:131]
  v_mfma_f32_16x16x32_bf16 v[132:135], v[48:51], v[116:119], v[132:135]
  v_mfma_f32_16x16x32_bf16 v[136:139], v[52:55], v[116:119], v[136:139]
  v_mfma_f32_16x16x32_bf16 v[140:143], v[56:59], v[116:119], v[140:143]
  v_mfma_f32_16x16x32_bf16 v[144:147], v[60:63], v[116:119], v[144:147]
  ds_read_b128 v[44:47], v2 offset:32256
  ds_read_b128 v[48:51], v2 offset:33280
  ds_read_b128 v[52:55], v2 offset:34304
  ds_read_b128 v[56:59], v2 offset:35328
  ds_read_b128 v[60:63], v3 offset:32256
  s_add_u32 m0, s60, 8192
  s_add_u32 s62, s40, 8192
  buffer_load_dwordx4 v4, s[12:15], s62 offen offset:0 sc1 lds
  s_waitcnt vmcnt(28)
  s_waitcnt lgkmcnt(5)
  v_mfma_f32_16x16x32_bf16 v[128:131], v[24:27], v[120:123], v[128:131]
  v_mfma_f32_16x16x32_bf16 v[132:135], v[28:31], v[120:123], v[132:135]
  v_mfma_f32_16x16x32_bf16 v[136:139], v[32:35], v[120:123], v[136:139]
  v_mfma_f32_16x16x32_bf16 v[140:143], v[36:39], v[120:123], v[140:143]
  v_mfma_f32_16x16x32_bf16 v[144:147], v[40:43], v[120:123], v[144:147]
  s_waitcnt vmcnt(4)
  v_readfirstlane_b32 s67, v11
  s_nop 0
  s_cmp_ge_u32 s67, 16
  s_cbranch_scc1 K4_GO
  s_cmp_eq_u32 s36, 0
  s_cbranch_scc0 K4_GO
  s_mov_b64 exec, 1
K4_POLL:
  buffer_load_dword v11, v9, s[24:27], s65 offen sc1
  s_add_u32 s66, s66, 1
  s_waitcnt vmcnt(0)
  v_readfirstlane_b32 s67, v11
  s_nop 0
  s_cmp_ge_u32 s67, 16
  s_cbranch_scc1 K4_GO0
  s_sleep 1
  s_cmp_lt_u32 s66, 0x40000
  s_cbranch_scc1 K4_POLL
K4_GO0:
  s_mov_b64 exec, -1
K4_GO:
  s_waitcnt vmcnt(10)
  s_barrier
  buffer_load_dwordx4 v[72:75], v4, s[8:11], s41 offen offset:2048 sc1
  buffer_load_dwordx4 v[76:79], v4, s[8:11], s41 offen offset:3072 sc1
  s_add_u32 s41, s41, 4096
  buffer_load_dwordx4 v[80:83], v4, s[8:11], s41 offen offset:0 sc1
  buffer_load_dwordx4 v[84:87], v4, s[8:11], s41 offen offset:1024 sc1
  buffer_load_dwordx4 v[88:91], v4, s[8:11], s41 offen offset:2048 sc1
  buffer_load_dwordx4 v[92:95], v4, s[8:11], s41 offen offset:3072 sc1
  s_add_u32 s41, s41, 4096
  buffer_load_dwordx4 v[96:99], v4, s[8:11], s41 offen offset:0 sc1
  buffer_load_dwordx4 v[100:103], v4, s[8:11], s41 offen offset:1024 sc1
  buffer_load_dwordx4 v[104:107], v4, s[8:11], s41 offen offset:2048 sc1
  buffer_load_dwordx4 v[108:111], v4, s[8:11], s41 offen offset:3072 sc1
  s_add_u32 s41, s41, 4096
  buffer_load_dwordx4 v[112:115], v4, s[8:11], s41 offen offset:0 sc1
  buffer_load_dwordx4 v[116:119], v4, s[8:11], s41 offen offset:1024 sc1
  buffer_load_dwordx4 v[120:123], v4, s[8:11], s41 offen offset:2048 sc1
  s_add_u32 s42, s42, 1
  s_and_b32 s52, s42, 3
  s_cmp_eq_u32 s52, 3
  s_cselect_b32 s52, 4294856704, s63
  v_add_u32 v2, s52, v2
  v_add_u32 v3, s52, v3
  s_add_u32 s40, s40, 36864
  s_add_u32 s39, s39, 36864
  s_cmp_eq_u32 s39, 147456
  s_cselect_b32 s39, 0, s39
  s_add_u32 s60, s58, s39
  ds_read_b128 v[24:27], v2 offset:0
  ds_read_b128 v[28:31], v2 offset:1024
  ds_read_b128 v[32:35], v2 offset:2048
  ds_read_b128 v[36:39], v2 offset:3072
  ds_read_b128 v[40:43], v3 offset:0
  s_add_u32 m0, s60, 0
  s_add_u32 s62, s40, 0
  buffer_load_dwordx4 v4, s[12:15], s62 offen offset:0 sc1 lds
  buffer_load_dwordx4 v4, s[12:15], s62 offen offset:1024 sc1 lds
  s_nop 0
  s_waitcnt lgkmcnt(5)
  v_mfma_f32_16x16x32_bf16 v[128:131], v[44:47], v[124:127], v[128:131]
  v_mfma_f32_16x16x32_bf16 v[132:135], v[48:51], v[124:127], v[132:135]
  v_mfma_f32_16x16x32_bf16 v[136:139], v[52:55], v[124:127], v[136:139]
  v_mfma_f32_16x16x32_bf16 v[140:143], v[56:59], v[124:127], v[140:143]
  v_mfma_f32_16x16x32_bf16 v[144:147], v[60:63], v[124:127], v[144:147]
  buffer_load_dwordx4 v[124:127], v4, s[8:11], s41 offen offset:3072 sc1
  s_add_u32 s41, s41, 4096
K4_LOOP:
  ds_read_b128 v[44:47], v2 offset:4608
  ds_read_b128 v[48:51], v2 offset:5632
  ds_read_b128 v[52:55], v2 offset:6656
  ds_read_b128 v[56:59], v2 offset:7680
  ds_read_b128 v[60:63], v3 offset:4608
  buffer_load_dwordx4 v4, s[12:15], s62 offen offset:2048 sc1 lds
  s_waitcnt vmcnt(33)
  s_waitcnt lgkmcnt(5)
  v_mfma_f32_16x16x32_bf16 v[128:131], v[24:27], v[64:67], v[128:131]
  v_mfma_f32_16x16x32_bf16 v[132:135], v[28:31], v[64:67], v[132:135]
  v_mfma_f32_16x16x32_bf16 v[136:139], v[32:35], v[64:67], v[136:139]
  v_mfma_f32_16x16x32_bf16 v[140:143], v[36:39], v[64:67], v[140:143]
  v_mfma_f32_16x16x32_bf16 v[144:147], v[40:43], v[64:67], v[144:147]
  buffer_load_dwordx4 v[64:67], v4, s[8:11], s41 offen offset:0 sc1
  ds_read_b128 v[24:27], v2 offset:9216
  ds_read_b128 v[28:31], v2 offset:10240
  ds_read_b128 v[32:35], v2 offset:11264
  ds_read_b128 v[36:39], v2 offset:12288
  ds_read_b128 v[40:43], v3 offset:9216
  buffer_load_dwordx4 v4, s[12:15], s62 offen offset:3072 sc1 lds
  s_waitcnt vmcnt(33)
  s_waitcnt lgkmcnt(5)
  v_mfma_f32_16x16x32_bf16 v[128:131], v[44:47], v[68:71], v[128:131]
  v_mfma_f32_16x16x32_bf16 v[132:135], v[48:51], v[68:71], v[132:135]
  v_mfma_f32_16x16x32_bf16 v[136:139], v[52:55], v[68:71], v[136:139]
  v_mfma_f32_16x16x32_bf16 v[140:143], v[56:59], v[68:71], v[140:143]
  v_mfma_f32_16x16x32_bf16 v[144:147], v[60:63], v[68:71], v[144:147]
  buffer_load_dwordx4 v[68:71], v4, s[8:11], s41 offen offset:1024 sc1
  s_cmp_eq_u32 s42, 20
  s_cbranch_scc1 K4_DONE
  s_cmp_eq_u32 s42, 2
  s_cbranch_scc0 K4_NOSW
  s_nop 7
  v_pk_mov_b32 v[148:149], v[128:129], v[128:129] op_sel:[0,1]
  v_pk_mov_b32 v[150:151], v[130:131], v[130:131] op_sel:[0,1]
  v_pk_mov_b32 v[152:153], v[132:133], v[132:133] op_sel:[0,1]
  v_pk_mov_b32 v[154:155], v[134:135], v[134:135] op_sel:[0,1]
  v_pk_mov_b32 v[156:157], v[136:137], v[136:137] op_sel:[0,1]
  v_pk_mov_b32 v[158:159], v[138:139], v[138:139] op_sel:[0,1]
  v_pk_mov_b32 v[160:161], v[140:141], v[140:141] op_sel:[0,1]
  v_pk_mov_b32 v[162:163], v[142:143], v[142:143] op_sel:[0,1]
  v_pk_mov_b32 v[164:165], v[144:145], v[144:145] op_sel:[0,1]
  v_pk_mov_b32 v[166:167], v[146:147], v[146:147] op_sel:[0,1]
  v_mov_b32 v128, 0
  v_mov_b32 v129, 0
  v_mov_b32 v130, 0
  v_mov_b32 v131, 0
  v_mov_b32 v132, 0
  v_mov_b32 v133, 0
  v_mov_b32 v134, 0
  v_mov_b32 v135, 0
  v_mov_b32 v136, 0
  v_mov_b32 v137, 0
  v_mov_b32 v138, 0
  v_mov_b32 v139, 0
  v_mov_b32 v140, 0
  v_mov_b32 v141, 0
  v_mov_b32 v142, 0
  v_mov_b32 v143, 0
  v_mov_b32 v144, 0
  v_mov_b32 v145, 0
  v_mov_b32 v146, 0
  v_mov_b32 v147, 0
  s_waitcnt vmcnt(4)
K4_NOSW:
  ds_read_b128 v[44:47], v2 offset:13824
  ds_read_b128 v[48:51], v2 offset:14848
  ds_read_b128 v[52:55], v2 offset:15872
  ds_read_b128 v[56:59], v2 offset:16896
  ds_read_b128 v[60:63], v3 offset:13824
  s_add_u32 m0, s60, 4096
  s_add_u32 s62, s40, 4096
  buffer_load_dwordx4 v4, s[12:15], s62 offen offset:0 sc1 lds
  s_waitcnt vmcnt(33)
  s_waitcnt lgkmcnt(5)
  v_mfma_f32_16x16x32_bf16 v[128:131], v[24:27], v[72:75], v[128:131]
  v_mfma_f32_16x16x32_bf16 v[132:135], v[28:31], v[72:75], v[132:135]
  v_mfma_f32_16x16x32_bf16 v[136:139], v[32:35], v[72:75], v[136:139]
  v_mfma_f32_16x16x32_bf16 v[140:143], v[36:39], v[72:75], v[140:143]
  v_mfma_f32_16x16x32_bf16 v[144:147], v[40:43], v[72:75], v[144:147]
  buffer_load_dwordx4 v[72:75], v4, s[8:11], s41 offen offset:2048 sc1
  ds_read_b128 v[24:27], v2 offset:18432
  ds_read_b128 v[28:31], v2 offset:19456
  ds_read_b128 v[32:35], v2 offset:20480
  ds_read_b128 v[36:39], v2 offset:21504
  ds_read_b128 v[40:43], v3 offset:18432
  buffer_load_dwordx4 v4, s[12:15], s62 offen offset:1024 sc1 lds
  s_waitcnt vmcnt(33)
  s_waitcnt lgkmcnt(5)
  v_mfma_f32_16x16x32_bf16 v[128:131], v[44:47], v[76:79], v[128:131]
  v_mfma_f32_16x16x32_bf16 v[132:135], v[48:51], v[76:79], v[132:135]
  v_mfma_f32_16x16x32_bf16 v[136:139], v[52:55], v[76:79], v[136:139]
  v_mfma_f32_16x16x32_bf16 v[140:143], v[56:59], v[76:79], v[140:143]
  v_mfma_f32_16x16x32_bf16 v[144:147], v[60:63], v[76:79], v[144:147]
  buffer_load_dwordx4 v[76:79], v4, s[8:11], s41 offen offset:3072 sc1
  s_add_u32 s41, s41, 4096
  ds_read_b128 v[44:47], v2 offset:23040
  ds_read_b128 v[48:51], v2 offset:24064
  ds_read_b128 v[52:55], v2 offset:25088
  ds_read_b128 v[56:59], v2 offset:26112
  ds_read_b128 v[60:63], v3 offset:23040
  buffer_load_dwordx4 v4, s[12:15], s62 offen offset:2048 sc1 lds
  s_waitcnt vmcnt(33)
  s_waitcnt lgkmcnt(5)
  v_mfma_f32_16x16x32_bf16 v[128:131], v[24:27], v[80:83], v[128:131]
  v_mfma_f32_16x16x32_bf16 v[132:135], v[28:31], v[80:83], v[132:135]
  v_mfma_f32_16x16x32_bf16 v[136:139], v[32:35], v[80:83], v[136:139]
  v_mfma_f32_16x16x32_bf16 v[140:143], v[36:39], v[80:83], v[140:143]
  v_mfma_f32_16x16x32_bf16 v[144:147], v[40:43], v[80:83], v[144:147]
  buffer_load_dwordx4 v[80:83], v4, s[8:11], s41 offen offset:0 sc1
  ds_read_b128 v[24:27], v2 offset:27648
  ds_read_b128 v[28:31], v2 offset:28672
  ds_read_b128 v[32:35], v2 offset:29696
  ds_read_b128 v[36:39], v2 offset:30720
  ds_read_b128 v[40:43], v3 offset:27648
  buffer_load_dwordx4 v4, s[12:15], s62 offen offset:3072 sc1 lds
  s_waitcnt vmcnt(33)
  s_waitcnt lgkmcnt(5)
  v_mfma_f32_16x16x32_bf16 v[128:131], v[44:47], v[84:87], v[128:131]
  v_mfma_f32_16x16x32_bf16 v[132:135], v[48:51], v[84:87], v[132:135]
  v_mfma_f32_16x16x32_bf16 v[136:139], v[52:55], v[84:87], v[136:139]
  v_mfma_f32_16x16x32_bf16 v[140:143], v[56:59], v[84:87], v[140:143]
  v_mfma_f32_16x16x32_bf16 v[144:147], v[60:63], v[84:87], v[144:147]
  buffer_load_dwordx4 v[84:87], v4, s[8:11], s41 offen offset:1024 sc1
  ds_read_b128 v[44:47], v2 offset:32256
  ds_read_b128 v[48:51], v2 offset:33280
  ds_read_b128 v[52:55], v2 offset:34304
  ds_read_b128 v[56:59], v2 offset:35328
  ds_read_b128 v[60:63], v3 offset:32256
  s_add_u32 m0, s60, 8192
  s_add_u32 s62, s40, 8192
  buffer_load_dwordx4 v4, s[12:15], s62 offen offset:0 sc1 lds
  s_waitcnt vmcnt(33)
  s_waitcnt lgkmcnt(5)
  v_mfma_f32_16x16x32_bf16 v[128:131], v[24:27], v[88:91], v[128:131]
  v_mfma_f32_16x16x32_bf16 v[132:135], v[28:31], v[88:91], v[132:135]
  v_mfma_f32_16x16x32_bf16 v[136:139], v[32:35], v[88:91], v[136:139]
  v_mfma_f32_16x16x32_bf16 v[140:143], v[36:39], v[88:91], v[140:143]
  v_mfma_f32_16x16x32_bf16 v[144:147], v[40:43], v[88:91], v[144:147]
  buffer_load_dwordx4 v[88:91], v4, s[8:11], s41 offen offset:2048 sc1
  s_waitcnt vmcnt(18)
  s_barrier
  s_add_u32 s42, s42, 1
  s_and_b32 s52, s42, 3
  s_cmp_eq_u32 s52, 3
  s_cselect_b32 s52, 4294856704, s63
  v_add_u32 v2, s52, v2
  v_add_u32 v3, s52, v3
  s_add_u32 s40, s40, 36864
  s_add_u32 s39, s39, 36864
  s_cmp_eq_u32 s39, 147456
  s_cselect_b32 s39, 0, s39
  s_add_u32 s60, s58, s39
  ds_read_b128 v[24:27], v2 offset:0
  ds_read_b128 v[28:31], v2 offset:1024
  ds_read_b128 v[32:35], v2 offset:2048
  ds_read_b128 v[36:39], v2 offset:3072
  ds_read_b128 v[40:43], v3 offset:0
  s_add_u32 m0, s60, 0
  s_add_u32 s62, s40, 0
  buffer_load_dwordx4 v4, s[12:15], s62 offen offset:0 sc1 lds
  buffer_load_dwordx4 v4, s[12:15], s62 offen offset:1024 sc1 lds
  s_waitcnt vmcnt(33)
  s_waitcnt lgkmcnt(5)
  v_mfma_f32_16x16x32_bf16 v[128:131], v[44:47], v[92:95], v[128:131]
  v_mfma_f32_16x16x32_bf16 v[132:135], v[48:51], v[92:95], v[132:135]
  v_mfma_f32_16x16x32_bf16 v[136:139], v[52:55], v[92:95], v[136:139]
  v_mfma_f32_16x16x32_bf16 v[140:143], v[56:59], v[92:95], v[140:143]
  v_mfma_f32_16x16x32_bf16 v[144:147], v[60:63], v[92:95], v[144:147]
  buffer_load_dwordx4 v[92:95], v4, s[8:11], s41 offen offset:3072 sc1
  s_add_u32 s41, s41, 4096
  ds_read_b128 v[44:47], v2 offset:4608
  ds_read_b128 v[48:51], v2 offset:5632
  ds_read_b128 v[52:55], v2 offset:6656
  ds_read_b128 v[56:59], v2 offset:7680
  ds_read_b128 v[60:63], v3 offset:4608
  buffer_load_dwordx4 v4, s[12:15], s62 offen offset:2048 sc1 lds
  s_waitcnt vmcnt(33)
  s_waitcnt lgkmcnt(5)
  v_mfma_f32_16x16x32_bf16 v[128:131], v[24:27], v[96:99], v[128:131]
  v_mfma_f32_16x16x32_bf16 v[132:135], v[28:31], v[96:99], v[132:135]
  v_mfma_f32_16x16x32_bf16 v[136:139], v[32:35], v[96:99], v[136:139]
  v_mfma_f32_16x16x32_bf16 v[140:143], v[36:39], v[96:99], v[140:143]
  v_mfma_f32_16x16x32_bf16 v[144:147], v[40:43], v[96:99], v[144:147]
  buffer_load_dwordx4 v[96:99], v4, s[8:11], s41 offen offset:0 sc1
  ds_read_b128 v[24:27], v2 offset:9216
  ds_read_b128 v[28:31], v2 offset:10240
  ds_read_b128 v[32:35], v2 offset:11264
  ds_read_b128 v[36:39], v2 offset:12288
  ds_read_b128 v[40:43], v3 offset:9216
  buffer_load_dwordx4 v4, s[12:15], s62 offen offset:3072 sc1 lds
  s_waitcnt vmcnt(33)
  s_waitcnt lgkmcnt(5)
  v_mfma_f32_16x16x32_bf16 v[128:131], v[44:47], v[100:103], v[128:131]
  v_mfma_f32_16x16x32_bf16 v[132:135], v[48:51], v[100:103], v[132:135]
  v_mfma_f32_16x16x32_bf16 v[136:139], v[52:55], v[100:103], v[136:139]
  v_mfma_f32_16x16x32_bf16 v[140:143], v[56:59], v[100:103], v[140:143]
  v_mfma_f32_16x16x32_bf16 v[144:147], v[60:63], v[100:103], v[144:147]
  buffer_load_dwordx4 v[100:103], v4, s[8:11], s41 offen offset:1024 sc1
  ds_read_b128 v[44:47], v2 offset:13824
  ds_read_b128 v[48:51], v2 offset:14848
  ds_read_b128 v[52:55], v2 offset:15872
  ds_read_b128 v[56:59], v2 offset:16896
  ds_read_b128 v[60:63], v3 offset:13824
  s_add_u32 m0, s60, 4096
  s_add_u32 s62, s40, 4096
  buffer_load_dwordx4 v4, s[12:15], s62 offen offset:0 sc1 lds
  s_waitcnt vmcnt(33)
  s_waitcnt lgkmcnt(5)
  v_mfma_f32_16x16x32_bf16 v[128:131], v[24:27], v[104:107], v[128:131]
  v_mfma_f32_16x16x32_bf16 v[132:135], v[28:31], v[104:107], v[132:135]
  v_mfma_f32_16x16x32_bf16 v[136:139], v[32:35], v[104:107], v[136:139]
  v_mfma_f32_16x16x32_bf16 v[140:143], v[36:39], v[104:107], v[140:143]
  v_mfma_f32_16x16x32_bf16 v[144:147], v[40:43], v[104:107], v[144:147]
  buffer_load_dwordx4 v[104:107], v4, s[8:11], s41 offen offset:2048 sc1
  ds_read_b128 v[24:27], v2 offset:18432
  ds_read_b128 v[28:31], v2 offset:19456
  ds_read_b128 v[32:35], v2 offset:20480
  ds_read_b128 v[36:39], v2 offset:21504
  ds_read_b128 v[40:43], v3 offset:18432
  buffer_load_dwordx4 v4, s[12:15], s62 offen offset:1024 sc1 lds
  s_waitcnt vmcnt(33)
  s_waitcnt lgkmcnt(5)
  v_mfma_f32_16x16x32_bf16 v[128:131], v[44:47], v[108:111], v[128:131]
  v_mfma_f32_16x16x32_bf16 v[132:135], v[48:51], v[108:111], v[132:135]
  v_mfma_f32_16x16x32_bf16 v[136:139], v[52:55], v[108:111], v[136:139]
  v_mfma_f32_16x16x32_bf16 v[140:143], v[56:59], v[108:111], v[140:143]
  v_mfma_f32_16x16x32_bf16 v[144:147], v[60:63], v[108:111], v[144:147]
  buffer_load_dwordx4 v[108:111], v4, s[8:11], s41 offen offset:3072 sc1
  s_add_u32 s41, s41, 4096
  ds_read_b128 v[44:47], v2 offset:23040
  ds_read_b128 v[48:51], v2 offset:24064
  ds_read_b128 v[52:55], v2 offset:25088
  ds_read_b128 v[56:59], v2 offset:26112
  ds_read_b128 v[60:63], v3 offset:23040
  buffer_load_dwordx4 v4, s[12:15], s62 offen offset:2048 sc1 lds
  s_waitcnt vmcnt(33)
  s_waitcnt lgkmcnt(5)
  v_mfma_f32_16x16x32_bf16 v[128:131], v[24:27], v[112:115], v[128:131]
  v_mfma_f32_16x16x32_bf16 v[132:135], v[28:31], v[112:115], v[132:135]
  v_mfma_f32_16x16x32_bf16 v[136:139], v[32:35], v[112:115], v[136:139]
  v_mfma_f32_16x16x32_bf16 v[140:143], v[36:39], v[112:115], v[140:143]
  v_mfma_f32_16x16x32_bf16 v[144:147], v[40:43], v[112:115], v[144:147]
  buffer_load_dwordx4 v[112:115], v4, s[8:11], s41 offen offset:0 sc1
  ds_read_b128 v[24:27], v2 offset:27648
  ds_read_b128 v[28:31], v2 offset:28672
  ds_read_b128 v[32:35], v2 offset:29696
  ds_read_b128 v[36:39], v2 offset:30720
  ds_read_b128 v[40:43], v3 offset:27648
  buffer_load_dwordx4 v4, s[12:15], s62 offen offset:3072 sc1 lds
  s_waitcnt vmcnt(33)
  s_waitcnt lgkmcnt(5)
  v_mfma_f32_16x16x32_bf16 v[128:131], v[44:47], v[116:119], v[128:131]
  v_mfma_f32_16x16x32_bf16 v[132:135], v[48:51], v[116:119], v[132:135]
  v_mfma_f32_16x16x32_bf16 v[136:139], v[52:55], v[116:119], v[136:139]
  v_mfma_f32_16x16x32_bf16 v[140:143], v[56:59], v[116:119], v[140:143]
  v_mfma_f32_16x16x32_bf16 v[144:147], v[60:63], v[116:119], v[144:147]
  buffer_load_dwordx4 v[116:119], v4, s[8:11], s41 offen offset:1024 sc1
  ds_read_b128 v[44:47], v2 offset:32256
  ds_read_b128 v[48:51], v2 offset:33280
  ds_read_b128 v[52:55], v2 offset:34304
  ds_read_b128 v[56:59], v2 offset:35328
  ds_read_b128 v[60:63], v3 offset:32256
  s_add_u32 m0, s60, 8192
  s_add_u32 s62, s40, 8192
  buffer_load_dwordx4 v4, s[12:15], s62 offen offset:0 sc1 lds
  s_waitcnt vmcnt(33)
  s_waitcnt lgkmcnt(5)
  v_mfma_f32_16x16x32_bf16 v[128:131], v[24:27], v[120:123], v[128:131]
  v_mfma_f32_16x16x32_bf16 v[132:135], v[28:31], v[120:123], v[132:135]
  v_mfma_f32_16x16x32_bf16 v[136:139], v[32:35], v[120:123], v[136:139]
  v_mfma_f32_16x16x32_bf16 v[140:143], v[36:39], v[120:123], v[140:143]
  v_mfma_f32_16x16x32_bf16 v[144:147], v[40:43], v[120:123], v[144:147]
  buffer_load_dwordx4 v[120:123], v4, s[8:11], s41 offen offset:2048 sc1
  s_waitcnt vmcnt(18)
  s_barrier
  s_add_u32 s42, s42, 1
  s_and_b32 s52, s42, 3
  s_cmp_eq_u32 s52, 3
  s_cselect_b32 s52, 4294856704, s63
  v_add_u32 v2, s52, v2
  v_add_u32 v3, s52, v3
  s_add_u32 s40, s40, 36864
  s_add_u32 s39, s39, 36864
  s_cmp_eq_u32 s39, 147456
  s_cselect_b32 s39, 0, s39
  s_add_u32 s60, s58, s39
  ds_read_b128 v[24:27], v2 offset:0
  ds_read_b128 v[28:31], v2 offset:1024
  ds_read_b128 v[32:35], v2 offset:2048
  ds_read_b128 v[36:39], v2 offset:3072
  ds_read_b128 v[40:43], v3 offset:0
  s_add_u32 m0, s60, 0
  s_add_u32 s62, s40, 0
  buffer_load_dwordx4 v4, s[12:15], s62 offen offset:0 sc1 lds
  buffer_load_dwordx4 v4, s[12:15], s62 offen offset:1024 sc1 lds
  s_waitcnt vmcnt(33)
  s_waitcnt lgkmcnt(5)
  v_mfma_f32_16x16x32_bf16 v[128:131], v[44:47], v[124:127], v[128:131]
  v_mfma_f32_16x16x32_bf16 v[132:135], v[48:51], v[124:127], v[132:135]
  v_mfma_f32_16x16x32_bf16 v[136:139], v[52:55], v[124:127], v[136:139]
  v_mfma_f32_16x16x32_bf16 v[140:143], v[56:59], v[124:127], v[140:143]
  v_mfma_f32_16x16x32_bf16 v[144:147], v[60:63], v[124:127], v[144:147]
  buffer_load_dwordx4 v[124:127], v4, s[8:11], s41 offen offset:3072 sc1
  s_add_u32 s41, s41, 4096
  s_branch K4_LOOP
K4_DONE:
  s_mov_b32 s16, s44
  s_mov_b32 s17, s45
  s_mov_b32 s18, 2359296
  s_mov_b32 s19, 0x20000
  s_mul_i32 s52, s36, 2560
  s_add_u32 s52, s52, 147456
  v_and_b32 v9, 15, v1
  v_mul_u32_u24 v9, 160, v9
  v_lshrrev_b32 v10, 4, v1
  v_lshl_add_u32 v9, v10, 3, v9
  v_add_u32 v9, s52, v9
  s_mov_b32 s53, 3216550459
  s_waitcnt lgkmcnt(0)
  v_lshlrev_b32 v24, 16, v180
  v_and_b32 v25, 0xffff0000, v180
  v_lshlrev_b32 v26, 16, v181
  v_and_b32 v27, 0xffff0000, v181
  v_lshlrev_b32 v28, 16, v182
  v_and_b32 v29, 0xffff0000, v182
  v_lshlrev_b32 v30, 16, v183
  v_and_b32 v31, 0xffff0000, v183
  v_lshlrev_b32 v32, 16, v184
  v_and_b32 v33, 0xffff0000, v184
  v_lshlrev_b32 v34, 16, v185
  v_and_b32 v35, 0xffff0000, v185
  v_lshlrev_b32 v36, 16, v186
  v_and_b32 v37, 0xffff0000, v186
  v_lshlrev_b32 v38, 16, v187
  v_and_b32 v39, 0xffff0000, v187
  v_lshlrev_b32 v40, 16, v188
  v_and_b32 v41, 0xffff0000, v188
  v_lshlrev_b32 v42, 16, v189
  v_and_b32 v43, 0xffff0000, v189
  v_pk_add_f32 v[128:129], v[128:129], v[24:25]
  v_pk_add_f32 v[130:131], v[130:131], v[26:27]
  v_pk_add_f32 v[132:133], v[132:133], v[28:29]
  v_pk_add_f32 v[134:135], v[134:135], v[30:31]
  v_pk_add_f32 v[136:137], v[136:137], v[32:33]
  v_pk_add_f32 v[138:139], v[138:139], v[34:35]
  v_pk_add_f32 v[140:141], v[140:141], v[36:37]
  v_pk_add_f32 v[142:143], v[142:143], v[38:39]
  v_pk_add_f32 v[144:145], v[144:145], v[40:41]
  v_pk_add_f32 v[146:147], v[146:147], v[42:43]
  v_mul_f32 v24, s53, v128
  v_mul_f32 v25, s53, v129
  v_mul_f32 v26, s53, v130
  v_mul_f32 v27, s53, v131
  v_mul_f32 v28, s53, v132
  v_mul_f32 v29, s53, v133
  v_mul_f32 v30, s53, v134
  v_mul_f32 v31, s53, v135
  v_mul_f32 v32, s53, v136
  v_mul_f32 v33, s53, v137
  v_mul_f32 v34, s53, v138
  v_mul_f32 v35, s53, v139
  v_mul_f32 v36, s53, v140
  v_mul_f32 v37, s53, v141
  v_mul_f32 v38, s53, v142
  v_mul_f32 v39, s53, v143
  v_mul_f32 v40, s53, v144
  v_mul_f32 v41, s53, v145
  v_mul_f32 v42, s53, v146
  v_mul_f32 v43, s53, v147
  v_exp_f32 v24, v24
  v_exp_f32 v25, v25
  v_exp_f32 v26, v26
  v_exp_f32 v27, v27
  v_exp_f32 v28, v28
  v_exp_f32 v29, v29
  v_exp_f32 v30, v30
  v_exp_f32 v31, v31
  v_exp_f32 v32, v32
  v_exp_f32 v33, v33
  v_exp_f32 v34, v34
  v_exp_f32 v35, v35
  v_exp_f32 v36, v36
  v_exp_f32 v37, v37
  v_exp_f32 v38, v38
  v_exp_f32 v39, v39
  v_exp_f32 v40, v40
  v_exp_f32 v41, v41
  v_exp_f32 v42, v42
  v_exp_f32 v43, v43
  v_pk_mul_f32 v[148:149], v[148:149], v[128:129]
  v_pk_mul_f32 v[150:151], v[150:151], v[130:131]
  v_pk_mul_f32 v[152:153], v[152:153], v[132:133]
  v_pk_mul_f32 v[154:155], v[154:155], v[134:135]
  v_pk_mul_f32 v[156:157], v[156:157], v[136:137]
  v_pk_mul_f32 v[158:159], v[158:159], v[138:139]
  v_pk_mul_f32 v[160:161], v[160:161], v[140:141]
  v_pk_mul_f32 v[162:163], v[162:163], v[142:143]
  v_pk_mul_f32 v[164:165], v[164:165], v[144:145]
  v_pk_mul_f32 v[166:167], v[166:167], v[146:147]
  v_pk_add_f32 v[24:25], v[24:25], 1.0 op_sel_hi:[1,0]
  v_pk_add_f32 v[26:27], v[26:27], 1.0 op_sel_hi:[1,0]
  v_pk_add_f32 v[28:29], v[28:29], 1.0 op_sel_hi:[1,0]
  v_pk_add_f32 v[30:31], v[30:31], 1.0 op_sel_hi:[1,0]
  v_pk_add_f32 v[32:33], v[32:33], 1.0 op_sel_hi:[1,0]
  v_pk_add_f32 v[34:35], v[34:35], 1.0 op_sel_hi:[1,0]
  v_pk_add_f32 v[36:37], v[36:37], 1.0 op_sel_hi:[1,0]
  v_pk_add_f32 v[38:39], v[38:39], 1.0 op_sel_hi:[1,0]
  v_pk_add_f32 v[40:41], v[40:41], 1.0 op_sel_hi:[1,0]
  v_pk_add_f32 v[42:43], v[42:43], 1.0 op_sel_hi:[1,0]
  v_rcp_f32 v24, v24
  v_rcp_f32 v25, v25
  v_rcp_f32 v26, v26
  v_rcp_f32 v27, v27
  v_rcp_f32 v28, v28
  v_rcp_f32 v29, v29
  v_rcp_f32 v30, v30
  v_rcp_f32 v31, v31
  v_rcp_f32 v32, v32
  v_rcp_f32 v33, v33
  v_rcp_f32 v34, v34
  v_rcp_f32 v35, v35
  v_rcp_f32 v36, v36
  v_rcp_f32 v37, v37
  v_rcp_f32 v38, v38
  v_rcp_f32 v39, v39
  v_rcp_f32 v40, v40
  v_rcp_f32 v41, v41
  v_rcp_f32 v42, v42
  v_rcp_f32 v43, v43
  v_pk_mul_f32 v[148:149], v[148:149], v[24:25]
  v_pk_mul_f32 v[150:151], v[150:151], v[26:27]
  v_pk_mul_f32 v[152:153], v[152:153], v[28:29]
  v_pk_mul_f32 v[154:155], v[154:155], v[30:31]
  v_pk_mul_f32 v[156:157], v[156:157], v[32:33]
  v_pk_mul_f32 v[158:159], v[158:159], v[34:35]
  v_pk_mul_f32 v[160:161], v[160:161], v[36:37]
  v_pk_mul_f32 v[162:163], v[162:163], v[38:39]
  v_pk_mul_f32 v[164:165], v[164:165], v[40:41]
  v_pk_mul_f32 v[166:167], v[166:167], v[42:43]
  v_cvt_pk_bf16_f32 v24, v148, v149
  v_cvt_pk_bf16_f32 v25, v150, v151
  ds_write_b64 v9, v[24:25] offset:0
  v_cvt_pk_bf16_f32 v26, v152, v153
  v_cvt_pk_bf16_f32 v27, v154, v155
  ds_write_b64 v9, v[26:27] offset:32
  v_cvt_pk_bf16_f32 v28, v156, v157
  v_cvt_pk_bf16_f32 v29, v158, v159
  ds_write_b64 v9, v[28:29] offset:64
  v_cvt_pk_bf16_f32 v30, v160, v161
  v_cvt_pk_bf16_f32 v31, v162, v163
  ds_write_b64 v9, v[30:31] offset:96
  v_cvt_pk_bf16_f32 v32, v164, v165
  v_cvt_pk_bf16_f32 v33, v166, v167
  ds_write_b64 v9, v[32:33] offset:128
  v_add_u32 v16, s52, v16
  ds_read_b128 v[44:47], v16
  v_add_u32 v17, s52, v17
  ds_read_b128 v[48:51], v17
  v_add_u32 v18, s52, v18
  ds_read_b128 v[52:55], v18
  s_waitcnt lgkmcnt(0)
  v_lshlrev_b32 v56, 16, v44
  v_and_b32 v57, 0xffff0000, v44
  v_lshlrev_b32 v58, 16, v168
  v_and_b32 v59, 0xffff0000, v168
  v_pk_add_f32 v[56:57], v[56:57], v[58:59]
  v_cvt_pk_bf16_f32 v44, v56, v57
  v_lshlrev_b32 v60, 16, v45
  v_and_b32 v61, 0xffff0000, v45
  v_lshlrev_b32 v62, 16, v169
  v_and_b32 v63, 0xffff0000, v169
  v_pk_add_f32 v[60:61], v[60:61], v[62:63]
  v_cvt_pk_bf16_f32 v45, v60, v61
  v_lshlrev_b32 v56, 16, v46
  v_and_b32 v57, 0xffff0000, v46
  v_lshlrev_b32 v58, 16, v170
  v_and_b32 v59, 0xffff0000, v170
  v_pk_add_f32 v[56:57], v[56:57], v[58:59]
  v_cvt_pk_bf16_f32 v46, v56, v57
  v_lshlrev_b32 v60, 16, v47
  v_and_b32 v61, 0xffff0000, v47
  v_lshlrev_b32 v62, 16, v171
  v_and_b32 v63, 0xffff0000, v171
  v_pk_add_f32 v[60:61], v[60:61], v[62:63]
  v_cvt_pk_bf16_f32 v47, v60, v61
  buffer_store_dwordx4 v[44:47], v5, s[16:19], s56 offen sc1
  v_lshlrev_b32 v56, 16, v48
  v_and_b32 v57, 0xffff0000, v48
  v_lshlrev_b32 v58, 16, v172
  v_and_b32 v59, 0xffff0000, v172
  v_pk_add_f32 v[56:57], v[56:57], v[58:59]
  v_cvt_pk_bf16_f32 v48, v56, v57
  v_lshlrev_b32 v60, 16, v49
  v_and_b32 v61, 0xffff0000, v49
  v_lshlrev_b32 v62, 16, v173
  v_and_b32 v63, 0xffff0000, v173
  v_pk_add_f32 v[60:61], v[60:61], v[62:63]
  v_cvt_pk_bf16_f32 v49, v60, v61
  v_lshlrev_b32 v56, 16, v50
  v_and_b32 v57, 0xffff0000, v50
  v_lshlrev_b32 v58, 16, v174
  v_and_b32 v59, 0xffff0000, v174
  v_pk_add_f32 v[56:57], v[56:57], v[58:59]
  v_cvt_pk_bf16_f32 v50, v56, v57
  v_lshlrev_b32 v60, 16, v51
  v_and_b32 v61, 0xffff0000, v51
  v_lshlrev_b32 v62, 16, v175
  v_and_b32 v63, 0xffff0000, v175
  v_pk_add_f32 v[60:61], v[60:61], v[62:63]
  v_cvt_pk_bf16_f32 v51, v60, v61
  buffer_store_dwordx4 v[48:51], v6, s[16:19], s56 offen sc1
  v_lshlrev_b32 v56, 16, v52
  v_and_b32 v57, 0xffff0000, v52
  v_lshlrev_b32 v58, 16, v176
  v_and_b32 v59, 0xffff0000, v176
  v_pk_add_f32 v[56:57], v[56:57], v[58:59]
  v_cvt_pk_bf16_f32 v52, v56, v57
  v_lshlrev_b32 v60, 16, v53
  v_and_b32 v61, 0xffff0000, v53
  v_lshlrev_b32 v62, 16, v177
  v_and_b32 v63, 0xffff0000, v177
  v_pk_add_f32 v[60:61], v[60:61], v[62:63]
  v_cvt_pk_bf16_f32 v53, v60, v61
  v_lshlrev_b32 v56, 16, v54
  v_and_b32 v57, 0xffff0000, v54
  v_lshlrev_b32 v58, 16, v178
  v_and_b32 v59, 0xffff0000, v178
  v_pk_add_f32 v[56:57], v[56:57], v[58:59]
  v_cvt_pk_bf16_f32 v54, v56, v57
  v_lshlrev_b32 v60, 16, v55
  v_and_b32 v61, 0xffff0000, v55
  v_lshlrev_b32 v62, 16, v179
  v_and_b32 v63, 0xffff0000, v179
  v_pk_add_f32 v[60:61], v[60:61], v[62:63]
  v_cvt_pk_bf16_f32 v55, v60, v61
  buffer_store_dwordx4 v[52:55], v7, s[16:19], s56 offen sc1
  s_branch K2_END2

CODE_END:
.section .rodata,"a"
.p2align 6
.amdhsa_kernel k1_kernel
  .amdhsa_next_free_vgpr 224
  .amdhsa_next_free_sgpr 76
  .amdhsa_accum_offset 224
  .amdhsa_group_segment_fixed_size 0
  .amdhsa_kernarg_size 88
  .amdhsa_user_sgpr_count 2
  .amdhsa_user_sgpr_kernarg_segment_ptr 1
  .amdhsa_system_sgpr_workgroup_id_x 1
  .amdhsa_float_denorm_mode_32 3
.end_amdhsa_kernel
.p2align 6
.amdhsa_kernel k234_kernel
  .amdhsa_next_free_vgpr 256
  .amdhsa_next_free_sgpr 76
  .amdhsa_accum_offset 256
  .amdhsa_group_segment_fixed_size 0
  .amdhsa_kernarg_size 88
  .amdhsa_user_sgpr_count 2
  .amdhsa_user_sgpr_kernarg_segment_ptr 1
  .amdhsa_system_sgpr_workgroup_id_x 1
  .amdhsa_float_denorm_mode_32 3
.end_amdhsa_kernel
```
